```python
import torch

def _softmax(x, axis=-1):
    return torch.softmax(x, dim=axis)
def _gelu(x):
    return torch.nn.functional.gelu(x, approximate="tanh")
def _silu(x):
    return torch.nn.functional.silu(x)
def _sigmoid(x):
    return torch.sigmoid(x)
def _layernorm(x, axis=-1, eps=1e-5):
    m = x.mean(dim=axis, keepdim=True)
    v = x.var(dim=axis, keepdim=True, unbiased=False)
    return (x - m) / torch.sqrt(v + eps)
def _scatter_add(tgt, idx, src, axis=0):
    return tgt.clone().index_add_(axis, idx, src)
def _segment_sum(src, seg, n):
    out = torch.zeros((n,) + src.shape[1:], dtype=src.dtype)
    return out.index_add_(0, seg, src)
def _pad(x, pw):
    flat = tuple(v for pair in reversed(pw) for v in pair)
    return torch.nn.functional.pad(x, flat)

kernel_name = 'gated_mix__gqa_block_cached__compressed_kv_cla__decode'

def setup_inputs():

    _w = (lambda a: (lambda t: t.to(torch.bfloat16) if t.is_floating_point() else t)(torch.as_tensor(a)))
    def _A_setup():
        B, Sq, D = 2, 1, 576
        Hq, Hkv, Sk, Dh = 32, 16, 4096, 128
        assert Hq % Hkv == 0, (Hq, Hkv)
        return {
            "x": _w((lambda *s: torch.randn(*s, dtype=torch.bfloat16) * 0.05)(B, Sq, D)),
            "k_cache": _w((lambda *s: torch.randn(*s, dtype=torch.bfloat16) * 6.4)(B, Hkv, Sk, Dh)),
            "v_cache": _w((lambda *s: torch.randn(*s, dtype=torch.bfloat16) * 0.8)(B, Hkv, Sk, Dh)),
            "wq": _w((lambda *s: torch.randn(*s, dtype=torch.bfloat16) * 6.4)(D, Hq * Dh) * (D ** -0.5)),
            "wo": _w((lambda *s: torch.randn(*s, dtype=torch.bfloat16) * 0.8)(Hq * Dh, D) * ((Hq * Dh) ** -0.5)),
        }
    _A_in = _A_setup()

    def _B_setup():
        B, H, Sq, Sk, D, M = 2, 32, 1, 4096, 128, 576
        Dc = 4 * D
        return {
            "x": _w((lambda *s: torch.randn(*s, dtype=torch.bfloat16) * 0.05)(B, Sq, M)),
            "c_kv": _w((lambda *s: torch.randn(*s, dtype=torch.bfloat16) * 0.8)(B, Sk, Dc)),
            "w_q": _w((lambda *s: torch.randn(*s, dtype=torch.bfloat16) * 6.4)(M, H, D) * (M ** -0.5)),
            "w_uk": _w((lambda *s: torch.randn(*s, dtype=torch.bfloat16) * 6.4)(Dc, H, D) * (Dc ** -0.5)),
            "w_uv": _w((lambda *s: torch.randn(*s, dtype=torch.bfloat16) * 0.8)(Dc, H, D) * (Dc ** -0.5)),
            "w_o": _w((lambda *s: torch.randn(*s, dtype=torch.bfloat16) * 0.8)(H, D, M) * ((H * D) ** -0.5)),
        }
    _B_in = _B_setup()

    return {
        "A_x": _A_in["x"],
        "A_k_cache": _A_in["k_cache"],
        "A_v_cache": _A_in["v_cache"],
        "A_wq": _A_in["wq"],
        "A_wo": _A_in["wo"],
        "B_x": _B_in["x"],
        "B_c_kv": _B_in["c_kv"],
        "B_w_q": _B_in["w_q"],
        "B_w_uk": _B_in["w_uk"],
        "B_w_uv": _B_in["w_uv"],
        "B_w_o": _B_in["w_o"],
        "gate_w": _w((lambda *s: torch.randn(*s, dtype=torch.bfloat16) * 0.05)(576) * 16.0),
    }

def reference(A_x, A_k_cache, A_v_cache, A_wq, A_wo, B_x, B_c_kv, B_w_q, B_w_uk, B_w_uv, B_w_o, gate_w):
    def _A_ref(x, k_cache, v_cache, wq, wo):
        B, Sq, D = x.shape
        Hq, Dh = 32, 128
        Hkv = k_cache.shape[1]
        rep = Hq // Hkv
        q = (lambda x, *d: x.permute(*d))((x @ wq).reshape(B, Sq, Hq, Dh), 0, 2, 1, 3)
        k = (lambda x, n, axis: torch.repeat_interleave(x, n, dim=axis))(k_cache, rep, axis=1)
        v = (lambda x, n, axis: torch.repeat_interleave(x, n, dim=axis))(v_cache, rep, axis=1)
        scores = torch.einsum("bhqd,bhkd->bhqk", q, k) * (Dh ** -0.5)
        p = _softmax(scores, axis=-1)
        o = torch.einsum("bhqk,bhkd->bhqd", p, v)
        return (lambda x, *d: x.permute(*d))(o, 0, 2, 1, 3).reshape(B, Sq, Hq * Dh) @ wo

    def _B_ref(x, c_kv, w_q, w_uk, w_uv, w_o):
        B, Sq, M = x.shape[0], x.shape[1], x.shape[2]
        Sk = c_kv.shape[1]
        H, D = w_q.shape[1], w_q.shape[2]
        q = torch.einsum("bqm,mhd->bhqd", x, w_q)
        k = torch.einsum("bkc,chd->bhkd", c_kv, w_uk)
        v = torch.einsum("bkc,chd->bhkd", c_kv, w_uv)
        scores = torch.einsum("bhqd,bhkd->bhqk", q, k) * (D ** -0.5)
        off = Sk - Sq
        qi = torch.arange(Sq)[:, None]
        kj = torch.arange(Sk)[None, :]
        cmask = kj <= (qi + off)
        scores = torch.where(cmask[None, None], scores, -1e9)
        p = _softmax(scores, axis=-1)
        ctx = torch.einsum("bhqk,bhkd->bhqd", p, v)
        return torch.einsum("bhqd,hdm->bqm", ctx, w_o)

    x = A_x
    g = _sigmoid((x * gate_w).sum(-1, keepdims=True))
    a = _A_ref(x, A_k_cache, A_v_cache, A_wq, A_wo)
    b = _B_ref(x, B_c_kv, B_w_q, B_w_uk, B_w_uv, B_w_o)
    return g * a + (1 - g) * b
```

```asm
; @launch grid=(256,1,1) block=(512,1,1) lds=163840
.amdgcn_target "amdgcn-amd-amdhsa--gfx950"
.text
.globl gated_mix__gqa_block_cached__compressed_kv_cla__decode_kernel
.p2align 8
.type gated_mix__gqa_block_cached__compressed_kv_cla__decode_kernel,@function
gated_mix__gqa_block_cached__compressed_kv_cla__decode_kernel:
    s_cmp_ge_u32 s2, 256
    s_cbranch_scc1 L_END
    s_load_dwordx16 s[8:23], s[0:1], 0
    s_load_dwordx8 s[24:31], s[0:1], 64
    s_load_dwordx4 s[32:35], s[0:1], 96
    s_load_dwordx2 s[36:37], s[0:1], 112
    v_lshrrev_b32 v1, 6, v0
    v_and_b32 v2, 63, v0
    s_nop 0
    v_readfirstlane_b32 s40, v1
    s_mov_b32 s41, 0x05040100
    s_mov_b32 s42, 0x07060302
    s_mov_b32 s43, 0x3e0293ee
    s_waitcnt lgkmcnt(0)
    s_cmp_lg_u32 s2, 0
    s_cbranch_scc1 NMX_1
    s_cmp_lg_u32 s40, 0
    s_cbranch_scc1 NMX_1
    s_memrealtime s[92:93]
    s_waitcnt lgkmcnt(0)
    s_or_b32 s92, s92, 1
    v_mov_b32 v3, 0
    v_mov_b32 v4, s92
    s_mov_b64 exec, 1
    global_store_dword v3, v4, s[34:35] sc1
    s_mov_b64 exec, -1
NMX_1:
    s_cmp_lt_u32 s2, 64
    s_cbranch_scc1 L_ROLE_B
    s_sub_u32 s50, s2, 64
    s_and_b32 s51, s50, 7
    s_lshr_b32 s52, s50, 3
    s_and_b32 s53, s52, 1
    s_lshl_b32 s44, s51, 1
    s_add_u32 s44, s44, s53
    s_lshr_b32 s52, s52, 1
    s_cmp_ge_u32 s52, 6
    s_cselect_b32 s45, 1, 0
    s_mul_i32 s53, s45, 6
    s_sub_u32 s46, s52, s53
    s_lshl_b32 s47, s45, 4
    s_add_u32 s47, s47, s44
    s_mul_i32 s56, s47, 6
    s_add_u32 s56, s56, s46
    s_add_u32 s56, s56, 64
    s_add_u32 s50, s40, 7
    s_and_b32 s50, s50, 7
    s_mul_i32 s50, s50, 6
    s_add_u32 s50, s50, s46
    s_mul_i32 s51, s50, 6
    s_mul_i32 s52, s50, 5
    s_add_u32 s52, s52, 16
    s_cmp_lt_u32 s50, 16
    s_cselect_b32 s48, s51, s52
    s_cselect_b32 s55, 5, 4
    s_cselect_b32 s54, 0, 0xff800000
    v_lshrrev_b32 v3, 5, v2
    v_and_b32 v4, 31, v2
    s_mul_i32 s50, s45, 6
    s_add_u32 s50, s50, s46
    s_mul_i32 s51, s50, 48
    s_mul_i32 s52, s40, 6
    s_add_u32 s51, s51, s52
    v_add_u32 v5, s51, v3
    v_lshlrev_b32 v6, 1, v5
    global_load_ushort v36, v6, s[8:9] offset:0
    global_load_ushort v37, v6, s[8:9] offset:4
    global_load_ushort v38, v6, s[8:9] offset:8
    global_load_ushort v39, v6, s[8:9] offset:1152
    global_load_ushort v40, v6, s[8:9] offset:1156
    global_load_ushort v41, v6, s[8:9] offset:1160
    v_lshlrev_b32 v5, 13, v5
    v_lshl_add_u32 v5, v4, 4, v5
    s_lshl_b32 s52, s44, 9
    v_add_u32 v5, s52, v5
    v_add_u32 v6, 0, v5
    global_load_dwordx4 v[64:67], v6, s[14:15] nt
    v_add_u32 v6, 16384, v5
    global_load_dwordx4 v[68:71], v6, s[14:15] nt
    v_add_u32 v6, 32768, v5
    global_load_dwordx4 v[72:75], v6, s[14:15] nt
    v_lshrrev_b32 v7, 4, v2
    v_and_b32 v8, 15, v2
    s_mul_i32 s51, s46, 96
    s_mul_i32 s52, s40, 12
    s_add_u32 s51, s51, s52
    v_add_u32 v5, s51, v7
    v_lshlrev_b32 v6, 1, v5
    global_load_ushort v42, v6, s[8:9] offset:0
    global_load_ushort v43, v6, s[8:9] offset:8
    global_load_ushort v44, v6, s[8:9] offset:16
    global_load_ushort v45, v6, s[8:9] offset:1152
    global_load_ushort v46, v6, s[8:9] offset:1160
    global_load_ushort v47, v6, s[8:9] offset:1168
    v_lshlrev_b32 v5, 13, v5
    v_lshl_add_u32 v5, v8, 4, v5
    s_lshl_b32 s52, s47, 8
    v_add_u32 v5, s52, v5
    v_add_u32 v6, 0, v5
    global_load_dwordx4 v[80:83], v6, s[22:23] nt
    v_add_u32 v6, 32768, v5
    global_load_dwordx4 v[84:87], v6, s[22:23] nt
    v_add_u32 v6, 65536, v5
    global_load_dwordx4 v[88:91], v6, s[22:23] nt
    v_mov_b32 v12, 0
    v_mov_b32 v160, 0
    v_mov_b32 v13, 0
    v_mov_b32 v161, 0
    v_mov_b32 v14, 0
    v_mov_b32 v162, 0
    v_mov_b32 v15, 0
    v_mov_b32 v163, 0
    v_mov_b32 v16, 0
    v_mov_b32 v164, 0
    v_mov_b32 v17, 0
    v_mov_b32 v165, 0
    v_mov_b32 v18, 0
    v_mov_b32 v166, 0
    v_mov_b32 v19, 0
    v_mov_b32 v167, 0
    v_mov_b32 v20, 0
    v_mov_b32 v168, 0
    v_mov_b32 v21, 0
    v_mov_b32 v169, 0
    v_mov_b32 v22, 0
    v_mov_b32 v170, 0
    v_mov_b32 v23, 0
    v_mov_b32 v171, 0
    v_mov_b32 v24, 0
    v_mov_b32 v172, 0
    v_mov_b32 v25, 0
    v_mov_b32 v173, 0
    v_mov_b32 v26, 0
    v_mov_b32 v174, 0
    v_mov_b32 v27, 0
    v_mov_b32 v175, 0
    s_lshl_b32 s50, s47, 12
    s_lshl_b32 s51, s48, 4
    s_add_u32 s50, s50, s51
    s_lshl_b32 s50, s50, 8
    v_and_b32 v9, 15, v2
    v_lshrrev_b32 v10, 4, v2
    v_lshlrev_b32 v11, 8, v9
    v_lshl_add_u32 v11, v10, 4, v11
    v_add_u32 v11, s50, v11
    v_lshlrev_b32 v60, 8, v10
    v_lshl_add_u32 v60, v9, 4, v60
    v_add_u32 v60, s50, v60
    s_lshl_b32 s55, s55, 12
    v_add_u32 v61, s55, v60
    s_waitcnt vmcnt(0)
    v_lshlrev_b32 v36, 16, v36
    v_lshlrev_b32 v37, 16, v37
    v_lshlrev_b32 v38, 16, v38
    v_lshlrev_b32 v39, 16, v39
    v_lshlrev_b32 v40, 16, v40
    v_lshlrev_b32 v41, 16, v41
    v_lshlrev_b32 v7, 16, v64
    v_and_b32 v8, 0xffff0000, v64
    v_fmac_f32 v12, v36, v7
    v_fmac_f32 v13, v36, v8
    v_fmac_f32 v20, v39, v7
    v_fmac_f32 v21, v39, v8
    v_lshlrev_b32 v7, 16, v65
    v_and_b32 v8, 0xffff0000, v65
    v_fmac_f32 v14, v36, v7
    v_fmac_f32 v15, v36, v8
    v_fmac_f32 v22, v39, v7
    v_fmac_f32 v23, v39, v8
    v_lshlrev_b32 v7, 16, v66
    v_and_b32 v8, 0xffff0000, v66
    v_fmac_f32 v16, v36, v7
    v_fmac_f32 v17, v36, v8
    v_fmac_f32 v24, v39, v7
    v_fmac_f32 v25, v39, v8
    v_lshlrev_b32 v7, 16, v67
    v_and_b32 v8, 0xffff0000, v67
    v_fmac_f32 v18, v36, v7
    v_fmac_f32 v19, v36, v8
    v_fmac_f32 v26, v39, v7
    v_fmac_f32 v27, v39, v8
    v_lshlrev_b32 v7, 16, v68
    v_and_b32 v8, 0xffff0000, v68
    v_fmac_f32 v12, v37, v7
    v_fmac_f32 v13, v37, v8
    v_fmac_f32 v20, v40, v7
    v_fmac_f32 v21, v40, v8
    v_lshlrev_b32 v7, 16, v69
    v_and_b32 v8, 0xffff0000, v69
    v_fmac_f32 v14, v37, v7
    v_fmac_f32 v15, v37, v8
    v_fmac_f32 v22, v40, v7
    v_fmac_f32 v23, v40, v8
    v_lshlrev_b32 v7, 16, v70
    v_and_b32 v8, 0xffff0000, v70
    v_fmac_f32 v16, v37, v7
    v_fmac_f32 v17, v37, v8
    v_fmac_f32 v24, v40, v7
    v_fmac_f32 v25, v40, v8
    v_lshlrev_b32 v7, 16, v71
    v_and_b32 v8, 0xffff0000, v71
    v_fmac_f32 v18, v37, v7
    v_fmac_f32 v19, v37, v8
    v_fmac_f32 v26, v40, v7
    v_fmac_f32 v27, v40, v8
    v_lshlrev_b32 v7, 16, v72
    v_and_b32 v8, 0xffff0000, v72
    v_fmac_f32 v12, v38, v7
    v_fmac_f32 v13, v38, v8
    v_fmac_f32 v20, v41, v7
    v_fmac_f32 v21, v41, v8
    v_lshlrev_b32 v7, 16, v73
    v_and_b32 v8, 0xffff0000, v73
    v_fmac_f32 v14, v38, v7
    v_fmac_f32 v15, v38, v8
    v_fmac_f32 v22, v41, v7
    v_fmac_f32 v23, v41, v8
    v_lshlrev_b32 v7, 16, v74
    v_and_b32 v8, 0xffff0000, v74
    v_fmac_f32 v16, v38, v7
    v_fmac_f32 v17, v38, v8
    v_fmac_f32 v24, v41, v7
    v_fmac_f32 v25, v41, v8
    v_lshlrev_b32 v7, 16, v75
    v_and_b32 v8, 0xffff0000, v75
    v_fmac_f32 v18, v38, v7
    v_fmac_f32 v19, v38, v8
    v_fmac_f32 v26, v41, v7
    v_fmac_f32 v27, v41, v8
    v_lshlrev_b32 v42, 16, v42
    v_lshlrev_b32 v43, 16, v43
    v_lshlrev_b32 v44, 16, v44
    v_lshlrev_b32 v45, 16, v45
    v_lshlrev_b32 v46, 16, v46
    v_lshlrev_b32 v47, 16, v47
    v_lshlrev_b32 v7, 16, v80
    v_and_b32 v8, 0xffff0000, v80
    v_fmac_f32 v160, v42, v7
    v_fmac_f32 v161, v42, v8
    v_fmac_f32 v168, v45, v7
    v_fmac_f32 v169, v45, v8
    v_lshlrev_b32 v7, 16, v81
    v_and_b32 v8, 0xffff0000, v81
    v_fmac_f32 v162, v42, v7
    v_fmac_f32 v163, v42, v8
    v_fmac_f32 v170, v45, v7
    v_fmac_f32 v171, v45, v8
    v_lshlrev_b32 v7, 16, v82
    v_and_b32 v8, 0xffff0000, v82
    v_fmac_f32 v164, v42, v7
    v_fmac_f32 v165, v42, v8
    v_fmac_f32 v172, v45, v7
    v_fmac_f32 v173, v45, v8
    v_lshlrev_b32 v7, 16, v83
    v_and_b32 v8, 0xffff0000, v83
    v_fmac_f32 v166, v42, v7
    v_fmac_f32 v167, v42, v8
    v_fmac_f32 v174, v45, v7
    v_fmac_f32 v175, v45, v8
    v_lshlrev_b32 v7, 16, v84
    v_and_b32 v8, 0xffff0000, v84
    v_fmac_f32 v160, v43, v7
    v_fmac_f32 v161, v43, v8
    v_fmac_f32 v168, v46, v7
    v_fmac_f32 v169, v46, v8
    v_lshlrev_b32 v7, 16, v85
    v_and_b32 v8, 0xffff0000, v85
    v_fmac_f32 v162, v43, v7
    v_fmac_f32 v163, v43, v8
    v_fmac_f32 v170, v46, v7
    v_fmac_f32 v171, v46, v8
    v_lshlrev_b32 v7, 16, v86
    v_and_b32 v8, 0xffff0000, v86
    v_fmac_f32 v164, v43, v7
    v_fmac_f32 v165, v43, v8
    v_fmac_f32 v172, v46, v7
    v_fmac_f32 v173, v46, v8
    v_lshlrev_b32 v7, 16, v87
    v_and_b32 v8, 0xffff0000, v87
    v_fmac_f32 v166, v43, v7
    v_fmac_f32 v167, v43, v8
    v_fmac_f32 v174, v46, v7
    v_fmac_f32 v175, v46, v8
    v_lshlrev_b32 v7, 16, v88
    v_and_b32 v8, 0xffff0000, v88
    v_fmac_f32 v160, v44, v7
    v_fmac_f32 v161, v44, v8
    v_fmac_f32 v168, v47, v7
    v_fmac_f32 v169, v47, v8
    v_lshlrev_b32 v7, 16, v89
    v_and_b32 v8, 0xffff0000, v89
    v_fmac_f32 v162, v44, v7
    v_fmac_f32 v163, v44, v8
    v_fmac_f32 v170, v47, v7
    v_fmac_f32 v171, v47, v8
    v_lshlrev_b32 v7, 16, v90
    v_and_b32 v8, 0xffff0000, v90
    v_fmac_f32 v164, v44, v7
    v_fmac_f32 v165, v44, v8
    v_fmac_f32 v172, v47, v7
    v_fmac_f32 v173, v47, v8
    v_lshlrev_b32 v7, 16, v91
    v_and_b32 v8, 0xffff0000, v91
    v_fmac_f32 v166, v44, v7
    v_fmac_f32 v167, v44, v8
    v_fmac_f32 v174, v47, v7
    v_fmac_f32 v175, v47, v8
    s_lshl_b32 s50, s40, 12
    s_add_u32 s50, s50, 65536
    v_lshlrev_b32 v5, 10, v10
    v_lshl_add_u32 v5, v9, 5, v5
    v_add_u32 v5, s50, v5
    ds_write_b128 v5, v[160:163] offset:0
    ds_write_b128 v5, v[164:167] offset:16
    ds_write_b128 v5, v[168:171] offset:512
    ds_write_b128 v5, v[172:175] offset:528
    s_lshl_b32 s50, s40, 12
    v_lshlrev_b32 v5, 11, v3
    v_lshl_add_u32 v5, v4, 5, v5
    v_add_u32 v5, s50, v5
    ds_write_b128 v5, v[12:15] offset:24576
    ds_write_b128 v5, v[16:19] offset:24592
    ds_write_b128 v5, v[20:23] offset:25600
    ds_write_b128 v5, v[24:27] offset:25616
    s_waitcnt lgkmcnt(0)
    s_barrier
    s_cmp_eq_u32 s40, 0
    s_cbranch_scc1 AW0_2
    s_cmp_lg_u32 s40, 1
    s_cbranch_scc1 AW1_4
    s_cmp_eq_u32 s2, 0
    s_cbranch_scc1 NX_5
    v_mov_b32 v6, 0
    s_mov_b32 s51, 0
NL_6:
    global_load_dword v7, v6, s[34:35] sc1
    s_waitcnt vmcnt(0)
    v_readfirstlane_b32 s92, v7
    s_nop 3
    s_cmp_lg_u32 s92, 0
    s_cbranch_scc1 NX_5
    s_add_u32 s51, s51, 1
    s_cmp_gt_u32 s51, 1048576
    s_cbranch_scc1 NX_5
    s_sleep 4
    s_branch NL_6
NX_5:
    v_lshlrev_b32 v5, 4, v2
    v_add_u32 v5, 65536, v5
    ds_read_b128 v[64:67], v5 offset:0
    ds_read_b128 v[68:71], v5 offset:1024
    ds_read_b128 v[72:75], v5 offset:2048
    ds_read_b128 v[76:79], v5 offset:3072
    ds_read_b128 v[80:83], v5 offset:4096
    ds_read_b128 v[84:87], v5 offset:5120
    ds_read_b128 v[88:91], v5 offset:6144
    ds_read_b128 v[92:95], v5 offset:7168
    ds_read_b128 v[96:99], v5 offset:8192
    ds_read_b128 v[100:103], v5 offset:9216
    ds_read_b128 v[104:107], v5 offset:10240
    ds_read_b128 v[108:111], v5 offset:11264
    ds_read_b128 v[112:115], v5 offset:12288
    ds_read_b128 v[116:119], v5 offset:13312
    ds_read_b128 v[120:123], v5 offset:14336
    ds_read_b128 v[124:127], v5 offset:15360
    ds_read_b128 v[128:131], v5 offset:16384
    ds_read_b128 v[132:135], v5 offset:17408
    ds_read_b128 v[136:139], v5 offset:18432
    ds_read_b128 v[140:143], v5 offset:19456
    ds_read_b128 v[144:147], v5 offset:20480
    ds_read_b128 v[148:151], v5 offset:21504
    ds_read_b128 v[152:155], v5 offset:22528
    ds_read_b128 v[156:159], v5 offset:23552
    ds_read_b128 v[160:163], v5 offset:24576
    ds_read_b128 v[164:167], v5 offset:25600
    ds_read_b128 v[168:171], v5 offset:26624
    ds_read_b128 v[172:175], v5 offset:27648
    ds_read_b128 v[176:179], v5 offset:28672
    ds_read_b128 v[180:183], v5 offset:29696
    ds_read_b128 v[184:187], v5 offset:30720
    ds_read_b128 v[188:191], v5 offset:31744
    s_waitcnt lgkmcnt(0)
    v_add_f32 v64, v64, v128
    v_add_f32 v65, v65, v129
    v_add_f32 v66, v66, v130
    v_add_f32 v67, v67, v131
    v_add_f32 v68, v68, v132
    v_add_f32 v69, v69, v133
    v_add_f32 v70, v70, v134
    v_add_f32 v71, v71, v135
    v_add_f32 v72, v72, v136
    v_add_f32 v73, v73, v137
    v_add_f32 v74, v74, v138
    v_add_f32 v75, v75, v139
    v_add_f32 v76, v76, v140
    v_add_f32 v77, v77, v141
    v_add_f32 v78, v78, v142
    v_add_f32 v79, v79, v143
    v_add_f32 v80, v80, v144
    v_add_f32 v81, v81, v145
    v_add_f32 v82, v82, v146
    v_add_f32 v83, v83, v147
    v_add_f32 v84, v84, v148
    v_add_f32 v85, v85, v149
    v_add_f32 v86, v86, v150
    v_add_f32 v87, v87, v151
    v_add_f32 v88, v88, v152
    v_add_f32 v89, v89, v153
    v_add_f32 v90, v90, v154
    v_add_f32 v91, v91, v155
    v_add_f32 v92, v92, v156
    v_add_f32 v93, v93, v157
    v_add_f32 v94, v94, v158
    v_add_f32 v95, v95, v159
    v_add_f32 v96, v96, v160
    v_add_f32 v97, v97, v161
    v_add_f32 v98, v98, v162
    v_add_f32 v99, v99, v163
    v_add_f32 v100, v100, v164
    v_add_f32 v101, v101, v165
    v_add_f32 v102, v102, v166
    v_add_f32 v103, v103, v167
    v_add_f32 v104, v104, v168
    v_add_f32 v105, v105, v169
    v_add_f32 v106, v106, v170
    v_add_f32 v107, v107, v171
    v_add_f32 v108, v108, v172
    v_add_f32 v109, v109, v173
    v_add_f32 v110, v110, v174
    v_add_f32 v111, v111, v175
    v_add_f32 v112, v112, v176
    v_add_f32 v113, v113, v177
    v_add_f32 v114, v114, v178
    v_add_f32 v115, v115, v179
    v_add_f32 v116, v116, v180
    v_add_f32 v117, v117, v181
    v_add_f32 v118, v118, v182
    v_add_f32 v119, v119, v183
    v_add_f32 v120, v120, v184
    v_add_f32 v121, v121, v185
    v_add_f32 v122, v122, v186
    v_add_f32 v123, v123, v187
    v_add_f32 v124, v124, v188
    v_add_f32 v125, v125, v189
    v_add_f32 v126, v126, v190
    v_add_f32 v127, v127, v191
    v_add_f32 v64, v64, v96
    v_add_f32 v65, v65, v97
    v_add_f32 v66, v66, v98
    v_add_f32 v67, v67, v99
    v_add_f32 v68, v68, v100
    v_add_f32 v69, v69, v101
    v_add_f32 v70, v70, v102
    v_add_f32 v71, v71, v103
    v_add_f32 v72, v72, v104
    v_add_f32 v73, v73, v105
    v_add_f32 v74, v74, v106
    v_add_f32 v75, v75, v107
    v_add_f32 v76, v76, v108
    v_add_f32 v77, v77, v109
    v_add_f32 v78, v78, v110
    v_add_f32 v79, v79, v111
    v_add_f32 v80, v80, v112
    v_add_f32 v81, v81, v113
    v_add_f32 v82, v82, v114
    v_add_f32 v83, v83, v115
    v_add_f32 v84, v84, v116
    v_add_f32 v85, v85, v117
    v_add_f32 v86, v86, v118
    v_add_f32 v87, v87, v119
    v_add_f32 v88, v88, v120
    v_add_f32 v89, v89, v121
    v_add_f32 v90, v90, v122
    v_add_f32 v91, v91, v123
    v_add_f32 v92, v92, v124
    v_add_f32 v93, v93, v125
    v_add_f32 v94, v94, v126
    v_add_f32 v95, v95, v127
    v_add_f32 v64, v64, v80
    v_add_f32 v65, v65, v81
    v_add_f32 v66, v66, v82
    v_add_f32 v67, v67, v83
    v_add_f32 v68, v68, v84
    v_add_f32 v69, v69, v85
    v_add_f32 v70, v70, v86
    v_add_f32 v71, v71, v87
    v_add_f32 v72, v72, v88
    v_add_f32 v73, v73, v89
    v_add_f32 v74, v74, v90
    v_add_f32 v75, v75, v91
    v_add_f32 v76, v76, v92
    v_add_f32 v77, v77, v93
    v_add_f32 v78, v78, v94
    v_add_f32 v79, v79, v95
    v_add_f32 v64, v64, v72
    v_add_f32 v65, v65, v73
    v_add_f32 v66, v66, v74
    v_add_f32 v67, v67, v75
    v_add_f32 v68, v68, v76
    v_add_f32 v69, v69, v77
    v_add_f32 v70, v70, v78
    v_add_f32 v71, v71, v79
    v_add_f32 v64, v64, v68
    v_add_f32 v65, v65, v69
    v_add_f32 v66, v66, v70
    v_add_f32 v67, v67, v71
    s_mul_i32 s50, s47, 6
    s_add_u32 s50, s50, s46
    s_lshl_b32 s50, s50, 10
    s_add_u32 s50, s50, 0x3a0000
    v_lshl_add_u32 v6, v2, 4, s50
    global_store_dwordx4 v6, v[64:67], s[36:37] sc1
    s_waitcnt vmcnt(0)
    s_lshl_b32 s50, s47, 7
    s_lshl_b32 s51, s46, 2
    s_add_u32 s50, s50, s51
    s_add_u32 s50, s50, 0x383000
    v_mov_b32 v6, s50
    v_mov_b32 v7, s92
    s_mov_b64 exec, 0x1
    global_store_dword v6, v7, s[36:37] sc1
    s_mov_b64 exec, -1
AW1_4:
    s_barrier
    v_add_u32 v6, 0, v11
    global_load_dwordx4 v[160:163], v6, s[10:11] offset:0 nt
    global_load_dwordx4 v[164:167], v6, s[10:11] offset:64 nt
    global_load_dwordx4 v[168:171], v6, s[10:11] offset:128 nt
    global_load_dwordx4 v[172:175], v6, s[10:11] offset:192 nt
    v_add_u32 v6, 4096, v11
    global_load_dwordx4 v[176:179], v6, s[10:11] offset:0 nt
    global_load_dwordx4 v[180:183], v6, s[10:11] offset:64 nt
    global_load_dwordx4 v[184:187], v6, s[10:11] offset:128 nt
    global_load_dwordx4 v[188:191], v6, s[10:11] offset:192 nt
    v_add_u32 v6, 8192, v11
    s_waitcnt vmcnt(7)
    global_load_dwordx4 v[192:195], v6, s[10:11] offset:0 nt
    s_waitcnt vmcnt(7)
    global_load_dwordx4 v[196:199], v6, s[10:11] offset:64 nt
    s_waitcnt vmcnt(7)
    global_load_dwordx4 v[200:203], v6, s[10:11] offset:128 nt
    s_waitcnt vmcnt(7)
    global_load_dwordx4 v[204:207], v6, s[10:11] offset:192 nt
    v_add_u32 v6, 12288, v11
    s_waitcnt vmcnt(7)
    global_load_dwordx4 v[208:211], v6, s[10:11] offset:0 nt
    s_waitcnt vmcnt(7)
    global_load_dwordx4 v[212:215], v6, s[10:11] offset:64 nt
    s_waitcnt vmcnt(7)
    global_load_dwordx4 v[216:219], v6, s[10:11] offset:128 nt
    s_waitcnt vmcnt(7)
    global_load_dwordx4 v[220:223], v6, s[10:11] offset:192 nt
    v_add_u32 v6, 16384, v11
    s_waitcnt vmcnt(7)
    global_load_dwordx4 v[224:227], v6, s[10:11] offset:0 nt
    s_waitcnt vmcnt(7)
    global_load_dwordx4 v[228:231], v6, s[10:11] offset:64 nt
    s_waitcnt vmcnt(7)
    global_load_dwordx4 v[232:235], v6, s[10:11] offset:128 nt
    s_waitcnt vmcnt(7)
    global_load_dwordx4 v[236:239], v6, s[10:11] offset:192 nt
    v_add_u32 v6, s55, v11
    s_waitcnt vmcnt(7)
    global_load_dwordx4 v[240:243], v6, s[10:11] offset:0 nt
    s_waitcnt vmcnt(7)
    global_load_dwordx4 v[244:247], v6, s[10:11] offset:64 nt
    s_waitcnt vmcnt(7)
    global_load_dwordx4 v[248:251], v6, s[10:11] offset:128 nt
    s_waitcnt vmcnt(7)
    global_load_dwordx4 v[252:255], v6, s[10:11] offset:192 nt
    v_add_u32 v6, 0, v60
    s_waitcnt vmcnt(7)
    global_load_dwordx4 v[64:67], v6, s[12:13] nt
    v_add_u32 v6, 1024, v60
    s_waitcnt vmcnt(7)
    global_load_dwordx4 v[68:71], v6, s[12:13] nt
    v_add_u32 v6, 2048, v60
    s_waitcnt vmcnt(7)
    global_load_dwordx4 v[72:75], v6, s[12:13] nt
    v_add_u32 v6, 3072, v60
    s_waitcnt vmcnt(7)
    global_load_dwordx4 v[76:79], v6, s[12:13] nt
    v_add_u32 v6, 4096, v60
    s_waitcnt vmcnt(7)
    global_load_dwordx4 v[80:83], v6, s[12:13] nt
    v_add_u32 v6, 5120, v60
    s_waitcnt vmcnt(7)
    global_load_dwordx4 v[84:87], v6, s[12:13] nt
    v_add_u32 v6, 6144, v60
    s_waitcnt vmcnt(7)
    global_load_dwordx4 v[88:91], v6, s[12:13] nt
    v_add_u32 v6, 7168, v60
    s_waitcnt vmcnt(7)
    global_load_dwordx4 v[92:95], v6, s[12:13] nt
    s_branch AWJ_3
AW0_2:
    s_cmp_eq_u32 s2, 0
    s_cbranch_scc1 NX_7
    v_mov_b32 v6, 0
    s_mov_b32 s51, 0
NL_8:
    global_load_dword v7, v6, s[34:35] sc1
    s_waitcnt vmcnt(0)
    v_readfirstlane_b32 s92, v7
    s_nop 3
    s_cmp_lg_u32 s92, 0
    s_cbranch_scc1 NX_7
    s_add_u32 s51, s51, 1
    s_cmp_gt_u32 s51, 1048576
    s_cbranch_scc1 NX_7
    s_sleep 4
    s_branch NL_8
NX_7:
    v_lshlrev_b32 v5, 4, v2
    ds_read_b128 v[64:67], v5 offset:24576
    ds_read_b128 v[68:71], v5 offset:25600
    ds_read_b128 v[72:75], v5 offset:26624
    ds_read_b128 v[76:79], v5 offset:27648
    ds_read_b128 v[80:83], v5 offset:28672
    ds_read_b128 v[84:87], v5 offset:29696
    ds_read_b128 v[88:91], v5 offset:30720
    ds_read_b128 v[92:95], v5 offset:31744
    ds_read_b128 v[96:99], v5 offset:32768
    ds_read_b128 v[100:103], v5 offset:33792
    ds_read_b128 v[104:107], v5 offset:34816
    ds_read_b128 v[108:111], v5 offset:35840
    ds_read_b128 v[112:115], v5 offset:36864
    ds_read_b128 v[116:119], v5 offset:37888
    ds_read_b128 v[120:123], v5 offset:38912
    ds_read_b128 v[124:127], v5 offset:39936
    ds_read_b128 v[128:131], v5 offset:40960
    ds_read_b128 v[132:135], v5 offset:41984
    ds_read_b128 v[136:139], v5 offset:43008
    ds_read_b128 v[140:143], v5 offset:44032
    ds_read_b128 v[144:147], v5 offset:45056
    ds_read_b128 v[148:151], v5 offset:46080
    ds_read_b128 v[152:155], v5 offset:47104
    ds_read_b128 v[156:159], v5 offset:48128
    ds_read_b128 v[160:163], v5 offset:49152
    ds_read_b128 v[164:167], v5 offset:50176
    ds_read_b128 v[168:171], v5 offset:51200
    ds_read_b128 v[172:175], v5 offset:52224
    ds_read_b128 v[176:179], v5 offset:53248
    ds_read_b128 v[180:183], v5 offset:54272
    ds_read_b128 v[184:187], v5 offset:55296
    ds_read_b128 v[188:191], v5 offset:56320
    s_waitcnt lgkmcnt(0)
    v_add_f32 v64, v64, v128
    v_add_f32 v65, v65, v129
    v_add_f32 v66, v66, v130
    v_add_f32 v67, v67, v131
    v_add_f32 v68, v68, v132
    v_add_f32 v69, v69, v133
    v_add_f32 v70, v70, v134
    v_add_f32 v71, v71, v135
    v_add_f32 v72, v72, v136
    v_add_f32 v73, v73, v137
    v_add_f32 v74, v74, v138
    v_add_f32 v75, v75, v139
    v_add_f32 v76, v76, v140
    v_add_f32 v77, v77, v141
    v_add_f32 v78, v78, v142
    v_add_f32 v79, v79, v143
    v_add_f32 v80, v80, v144
    v_add_f32 v81, v81, v145
    v_add_f32 v82, v82, v146
    v_add_f32 v83, v83, v147
    v_add_f32 v84, v84, v148
    v_add_f32 v85, v85, v149
    v_add_f32 v86, v86, v150
    v_add_f32 v87, v87, v151
    v_add_f32 v88, v88, v152
    v_add_f32 v89, v89, v153
    v_add_f32 v90, v90, v154
    v_add_f32 v91, v91, v155
    v_add_f32 v92, v92, v156
    v_add_f32 v93, v93, v157
    v_add_f32 v94, v94, v158
    v_add_f32 v95, v95, v159
    v_add_f32 v96, v96, v160
    v_add_f32 v97, v97, v161
    v_add_f32 v98, v98, v162
    v_add_f32 v99, v99, v163
    v_add_f32 v100, v100, v164
    v_add_f32 v101, v101, v165
    v_add_f32 v102, v102, v166
    v_add_f32 v103, v103, v167
    v_add_f32 v104, v104, v168
    v_add_f32 v105, v105, v169
    v_add_f32 v106, v106, v170
    v_add_f32 v107, v107, v171
    v_add_f32 v108, v108, v172
    v_add_f32 v109, v109, v173
    v_add_f32 v110, v110, v174
    v_add_f32 v111, v111, v175
    v_add_f32 v112, v112, v176
    v_add_f32 v113, v113, v177
    v_add_f32 v114, v114, v178
    v_add_f32 v115, v115, v179
    v_add_f32 v116, v116, v180
    v_add_f32 v117, v117, v181
    v_add_f32 v118, v118, v182
    v_add_f32 v119, v119, v183
    v_add_f32 v120, v120, v184
    v_add_f32 v121, v121, v185
    v_add_f32 v122, v122, v186
    v_add_f32 v123, v123, v187
    v_add_f32 v124, v124, v188
    v_add_f32 v125, v125, v189
    v_add_f32 v126, v126, v190
    v_add_f32 v127, v127, v191
    v_add_f32 v64, v64, v96
    v_add_f32 v65, v65, v97
    v_add_f32 v66, v66, v98
    v_add_f32 v67, v67, v99
    v_add_f32 v68, v68, v100
    v_add_f32 v69, v69, v101
    v_add_f32 v70, v70, v102
    v_add_f32 v71, v71, v103
    v_add_f32 v72, v72, v104
    v_add_f32 v73, v73, v105
    v_add_f32 v74, v74, v106
    v_add_f32 v75, v75, v107
    v_add_f32 v76, v76, v108
    v_add_f32 v77, v77, v109
    v_add_f32 v78, v78, v110
    v_add_f32 v79, v79, v111
    v_add_f32 v80, v80, v112
    v_add_f32 v81, v81, v113
    v_add_f32 v82, v82, v114
    v_add_f32 v83, v83, v115
    v_add_f32 v84, v84, v116
    v_add_f32 v85, v85, v117
    v_add_f32 v86, v86, v118
    v_add_f32 v87, v87, v119
    v_add_f32 v88, v88, v120
    v_add_f32 v89, v89, v121
    v_add_f32 v90, v90, v122
    v_add_f32 v91, v91, v123
    v_add_f32 v92, v92, v124
    v_add_f32 v93, v93, v125
    v_add_f32 v94, v94, v126
    v_add_f32 v95, v95, v127
    v_add_f32 v64, v64, v80
    v_add_f32 v65, v65, v81
    v_add_f32 v66, v66, v82
    v_add_f32 v67, v67, v83
    v_add_f32 v68, v68, v84
    v_add_f32 v69, v69, v85
    v_add_f32 v70, v70, v86
    v_add_f32 v71, v71, v87
    v_add_f32 v72, v72, v88
    v_add_f32 v73, v73, v89
    v_add_f32 v74, v74, v90
    v_add_f32 v75, v75, v91
    v_add_f32 v76, v76, v92
    v_add_f32 v77, v77, v93
    v_add_f32 v78, v78, v94
    v_add_f32 v79, v79, v95
    v_add_f32 v64, v64, v72
    v_add_f32 v65, v65, v73
    v_add_f32 v66, v66, v74
    v_add_f32 v67, v67, v75
    v_add_f32 v68, v68, v76
    v_add_f32 v69, v69, v77
    v_add_f32 v70, v70, v78
    v_add_f32 v71, v71, v79
    s_mul_i32 s50, s45, 6
    s_add_u32 s50, s50, s46
    s_mul_i32 s51, s44, 12
    s_add_u32 s50, s50, s51
    s_lshl_b32 s50, s50, 11
    s_add_u32 s50, s50, 0x300000
    v_add_u32 v6, s50, v5
    global_store_dwordx4 v6, v[64:67], s[36:37] sc1
    global_store_dwordx4 v6, v[68:71], s[36:37] offset:1024 sc1
    s_waitcnt vmcnt(0)
    s_mul_i32 s50, s45, 6
    s_add_u32 s50, s50, s46
    s_lshl_b32 s50, s50, 2
    s_lshl_b32 s51, s44, 7
    s_add_u32 s51, s51, 0x380000
    s_add_u32 s50, s50, s51
    v_mov_b32 v6, s50
    v_mov_b32 v7, s92
    s_mov_b64 exec, 0x1
    global_store_dword v6, v7, s[36:37] sc1
    s_mov_b64 exec, -1
    v_lshl_add_u32 v6, v2, 2, s51
    s_mov_b32 s51, 0
    s_mov_b64 exec, 0xfff
POLL_9:
    global_load_dword v7, v6, s[36:37] sc1
    s_waitcnt vmcnt(0)
    v_cmp_ne_u32 vcc, s92, v7
    s_nop 1
    s_cmp_eq_u64 vcc, 0
    s_cbranch_scc1 POLLX_10
    s_add_u32 s51, s51, 1
    s_cmp_gt_u32 s51, 1048576
    s_cbranch_scc1 POLLX_10
    s_sleep 2
    s_branch POLL_9
POLLX_10:
    s_mov_b64 exec, -1
    s_mul_i32 s50, s44, 24576
    s_lshl_b32 s51, s45, 10
    s_add_u32 s50, s50, s51
    s_add_u32 s50, s50, 0x300000
    v_add_u32 v6, s50, v5
    v_add_u32 v7, 0, v6
    global_load_dwordx4 v[160:163], v7, s[36:37] sc1
    v_add_u32 v7, 2048, v6
    global_load_dwordx4 v[164:167], v7, s[36:37] sc1
    v_add_u32 v7, 4096, v6
    global_load_dwordx4 v[168:171], v7, s[36:37] sc1
    v_add_u32 v7, 6144, v6
    global_load_dwordx4 v[172:175], v7, s[36:37] sc1
    v_add_u32 v7, 8192, v6
    global_load_dwordx4 v[176:179], v7, s[36:37] sc1
    v_add_u32 v7, 10240, v6
    global_load_dwordx4 v[180:183], v7, s[36:37] sc1
    v_add_u32 v7, 12288, v6
    global_load_dwordx4 v[184:187], v7, s[36:37] sc1
    v_add_u32 v7, 14336, v6
    global_load_dwordx4 v[188:191], v7, s[36:37] sc1
    v_add_u32 v7, 16384, v6
    global_load_dwordx4 v[192:195], v7, s[36:37] sc1
    v_add_u32 v7, 18432, v6
    global_load_dwordx4 v[196:199], v7, s[36:37] sc1
    v_add_u32 v7, 20480, v6
    global_load_dwordx4 v[200:203], v7, s[36:37] sc1
    v_add_u32 v7, 22528, v6
    global_load_dwordx4 v[204:207], v7, s[36:37] sc1
    s_waitcnt vmcnt(0)
    v_add_f32 v160, v160, v164
    v_add_f32 v161, v161, v165
    v_add_f32 v162, v162, v166
    v_add_f32 v163, v163, v167
    v_add_f32 v160, v160, v168
    v_add_f32 v161, v161, v169
    v_add_f32 v162, v162, v170
    v_add_f32 v163, v163, v171
    v_add_f32 v160, v160, v172
    v_add_f32 v161, v161, v173
    v_add_f32 v162, v162, v174
    v_add_f32 v163, v163, v175
    v_add_f32 v160, v160, v176
    v_add_f32 v161, v161, v177
    v_add_f32 v162, v162, v178
    v_add_f32 v163, v163, v179
    v_add_f32 v160, v160, v180
    v_add_f32 v161, v161, v181
    v_add_f32 v162, v162, v182
    v_add_f32 v163, v163, v183
    v_add_f32 v160, v160, v184
    v_add_f32 v161, v161, v185
    v_add_f32 v162, v162, v186
    v_add_f32 v163, v163, v187
    v_add_f32 v160, v160, v188
    v_add_f32 v161, v161, v189
    v_add_f32 v162, v162, v190
    v_add_f32 v163, v163, v191
    v_add_f32 v160, v160, v192
    v_add_f32 v161, v161, v193
    v_add_f32 v162, v162, v194
    v_add_f32 v163, v163, v195
    v_add_f32 v160, v160, v196
    v_add_f32 v161, v161, v197
    v_add_f32 v162, v162, v198
    v_add_f32 v163, v163, v199
    v_add_f32 v160, v160, v200
    v_add_f32 v161, v161, v201
    v_add_f32 v162, v162, v202
    v_add_f32 v163, v163, v203
    v_add_f32 v160, v160, v204
    v_add_f32 v161, v161, v205
    v_add_f32 v162, v162, v206
    v_add_f32 v163, v163, v207
    v_cvt_pk_bf16_f32 v6, v160, v161
    v_cvt_pk_bf16_f32 v7, v162, v163
    v_lshlrev_b32 v5, 3, v2
    ds_write_b64 v5, v[6:7] offset:16384
    s_waitcnt lgkmcnt(0)
    s_barrier
    v_add_u32 v6, 0, v11
    global_load_dwordx4 v[160:163], v6, s[10:11] offset:0 nt
    global_load_dwordx4 v[164:167], v6, s[10:11] offset:64 nt
    global_load_dwordx4 v[168:171], v6, s[10:11] offset:128 nt
    global_load_dwordx4 v[172:175], v6, s[10:11] offset:192 nt
    v_add_u32 v6, 4096, v11
    global_load_dwordx4 v[176:179], v6, s[10:11] offset:0 nt
    global_load_dwordx4 v[180:183], v6, s[10:11] offset:64 nt
    global_load_dwordx4 v[184:187], v6, s[10:11] offset:128 nt
    global_load_dwordx4 v[188:191], v6, s[10:11] offset:192 nt
    v_add_u32 v6, 8192, v11
    s_waitcnt vmcnt(7)
    global_load_dwordx4 v[192:195], v6, s[10:11] offset:0 nt
    s_waitcnt vmcnt(7)
    global_load_dwordx4 v[196:199], v6, s[10:11] offset:64 nt
    s_waitcnt vmcnt(7)
    global_load_dwordx4 v[200:203], v6, s[10:11] offset:128 nt
    s_waitcnt vmcnt(7)
    global_load_dwordx4 v[204:207], v6, s[10:11] offset:192 nt
    v_add_u32 v6, 12288, v11
    s_waitcnt vmcnt(7)
    global_load_dwordx4 v[208:211], v6, s[10:11] offset:0 nt
    s_waitcnt vmcnt(7)
    global_load_dwordx4 v[212:215], v6, s[10:11] offset:64 nt
    s_waitcnt vmcnt(7)
    global_load_dwordx4 v[216:219], v6, s[10:11] offset:128 nt
    s_waitcnt vmcnt(7)
    global_load_dwordx4 v[220:223], v6, s[10:11] offset:192 nt
    v_add_u32 v6, 16384, v11
    s_waitcnt vmcnt(7)
    global_load_dwordx4 v[224:227], v6, s[10:11] offset:0 nt
    s_waitcnt vmcnt(7)
    global_load_dwordx4 v[228:231], v6, s[10:11] offset:64 nt
    s_waitcnt vmcnt(7)
    global_load_dwordx4 v[232:235], v6, s[10:11] offset:128 nt
    s_waitcnt vmcnt(7)
    global_load_dwordx4 v[236:239], v6, s[10:11] offset:192 nt
    v_add_u32 v6, s55, v11
    s_waitcnt vmcnt(7)
    global_load_dwordx4 v[240:243], v6, s[10:11] offset:0 nt
    s_waitcnt vmcnt(7)
    global_load_dwordx4 v[244:247], v6, s[10:11] offset:64 nt
    s_waitcnt vmcnt(7)
    global_load_dwordx4 v[248:251], v6, s[10:11] offset:128 nt
    s_waitcnt vmcnt(7)
    global_load_dwordx4 v[252:255], v6, s[10:11] offset:192 nt
    v_add_u32 v6, 0, v60
    s_waitcnt vmcnt(7)
    global_load_dwordx4 v[64:67], v6, s[12:13] nt
    v_add_u32 v6, 1024, v60
    s_waitcnt vmcnt(7)
    global_load_dwordx4 v[68:71], v6, s[12:13] nt
    v_add_u32 v6, 2048, v60
    s_waitcnt vmcnt(7)
    global_load_dwordx4 v[72:75], v6, s[12:13] nt
    v_add_u32 v6, 3072, v60
    s_waitcnt vmcnt(7)
    global_load_dwordx4 v[76:79], v6, s[12:13] nt
    v_add_u32 v6, 4096, v60
    s_waitcnt vmcnt(7)
    global_load_dwordx4 v[80:83], v6, s[12:13] nt
    v_add_u32 v6, 5120, v60
    s_waitcnt vmcnt(7)
    global_load_dwordx4 v[84:87], v6, s[12:13] nt
    v_add_u32 v6, 6144, v60
    s_waitcnt vmcnt(7)
    global_load_dwordx4 v[88:91], v6, s[12:13] nt
    v_add_u32 v6, 7168, v60
    s_waitcnt vmcnt(7)
    global_load_dwordx4 v[92:95], v6, s[12:13] nt
AWJ_3:
    v_mov_b32 v12, 0
    v_mov_b32 v13, 0
    v_mov_b32 v14, 0
    v_mov_b32 v15, 0
    v_mov_b32 v16, 0
    v_mov_b32 v17, 0
    v_mov_b32 v18, 0
    v_mov_b32 v19, 0
    v_mov_b32 v20, 0
    v_mov_b32 v21, 0
    v_mov_b32 v22, 0
    v_mov_b32 v23, 0
    v_mov_b32 v24, 0
    v_mov_b32 v25, 0
    v_mov_b32 v26, 0
    v_mov_b32 v27, 0
    v_lshlrev_b32 v5, 8, v9
    v_lshl_add_u32 v5, v10, 4, v5
    v_cmp_gt_u32 vcc, 2, v9
    s_and_saveexec_b64 s[58:59], vcc
    ds_read_b128 v[12:15], v5 offset:16384
    ds_read_b128 v[16:19], v5 offset:16448
    ds_read_b128 v[20:23], v5 offset:16512
    ds_read_b128 v[24:27], v5 offset:16576
    s_mov_b64 exec, s[58:59]
    v_add_u32 v6, 8192, v60
    s_waitcnt vmcnt(7)
    global_load_dwordx4 v[96:99], v6, s[12:13] nt
    v_add_u32 v6, 9216, v60
    s_waitcnt vmcnt(7)
    global_load_dwordx4 v[100:103], v6, s[12:13] nt
    v_add_u32 v6, 10240, v60
    s_waitcnt vmcnt(7)
    global_load_dwordx4 v[104:107], v6, s[12:13] nt
    v_add_u32 v6, 11264, v60
    s_waitcnt vmcnt(7)
    global_load_dwordx4 v[108:111], v6, s[12:13] nt
    s_waitcnt lgkmcnt(0)
    s_waitcnt vmcnt(12)
    v_mfma_f32_16x16x32_bf16 v[36:39], v[12:15], v[160:163], 0
    v_mfma_f32_16x16x32_bf16 v[36:39], v[16:19], v[164:167], v[36:39]
    v_mfma_f32_16x16x32_bf16 v[36:39], v[20:23], v[168:171], v[36:39]
    v_mfma_f32_16x16x32_bf16 v[36:39], v[24:27], v[172:175], v[36:39]
    v_mfma_f32_16x16x32_bf16 v[40:43], v[12:15], v[176:179], 0
    v_mfma_f32_16x16x32_bf16 v[40:43], v[16:19], v[180:183], v[40:43]
    v_mfma_f32_16x16x32_bf16 v[40:43], v[20:23], v[184:187], v[40:43]
    v_mfma_f32_16x16x32_bf16 v[40:43], v[24:27], v[188:191], v[40:43]
    v_mfma_f32_16x16x32_bf16 v[44:47], v[12:15], v[192:195], 0
    v_mfma_f32_16x16x32_bf16 v[44:47], v[16:19], v[196:199], v[44:47]
    v_mfma_f32_16x16x32_bf16 v[44:47], v[20:23], v[200:203], v[44:47]
    v_mfma_f32_16x16x32_bf16 v[44:47], v[24:27], v[204:207], v[44:47]
    v_mfma_f32_16x16x32_bf16 v[48:51], v[12:15], v[208:211], 0
    v_mfma_f32_16x16x32_bf16 v[48:51], v[16:19], v[212:215], v[48:51]
    v_mfma_f32_16x16x32_bf16 v[48:51], v[20:23], v[216:219], v[48:51]
    v_mfma_f32_16x16x32_bf16 v[48:51], v[24:27], v[220:223], v[48:51]
    v_mfma_f32_16x16x32_bf16 v[52:55], v[12:15], v[224:227], 0
    v_mfma_f32_16x16x32_bf16 v[52:55], v[16:19], v[228:231], v[52:55]
    v_mfma_f32_16x16x32_bf16 v[52:55], v[20:23], v[232:235], v[52:55]
    v_mfma_f32_16x16x32_bf16 v[52:55], v[24:27], v[236:239], v[52:55]
    v_mfma_f32_16x16x32_bf16 v[56:59], v[12:15], v[240:243], 0
    v_mfma_f32_16x16x32_bf16 v[56:59], v[16:19], v[244:247], v[56:59]
    v_mfma_f32_16x16x32_bf16 v[56:59], v[20:23], v[248:251], v[56:59]
    v_mfma_f32_16x16x32_bf16 v[56:59], v[24:27], v[252:255], v[56:59]
    v_add_u32 v6, 12288, v60
    s_waitcnt vmcnt(7)
    global_load_dwordx4 v[112:115], v6, s[12:13] nt
    v_add_u32 v6, 13312, v60
    s_waitcnt vmcnt(7)
    global_load_dwordx4 v[116:119], v6, s[12:13] nt
    v_add_u32 v6, 14336, v60
    s_waitcnt vmcnt(7)
    global_load_dwordx4 v[120:123], v6, s[12:13] nt
    v_add_u32 v6, 15360, v60
    s_waitcnt vmcnt(7)
    global_load_dwordx4 v[124:127], v6, s[12:13] nt
    s_nop 7
    v_add_f32 v56, s54, v56
    v_add_f32 v57, s54, v57
    v_max3_f32 v3, v36, v40, v44
    v_max3_f32 v3, v3, v48, v52
    v_max_f32 v3, v3, v56
    s_nop 1
    v_max_f32_dpp v3, v3, v3 row_ror:8 row_mask:0xf bank_mask:0xf
    s_nop 1
    v_max_f32_dpp v3, v3, v3 row_ror:4 row_mask:0xf bank_mask:0xf
    s_nop 1
    v_max_f32_dpp v3, v3, v3 row_ror:2 row_mask:0xf bank_mask:0xf
    s_nop 1
    v_max_f32_dpp v3, v3, v3 row_ror:1 row_mask:0xf bank_mask:0xf
    v_max3_f32 v4, v37, v41, v45
    v_max3_f32 v4, v4, v49, v53
    v_max_f32 v4, v4, v57
    s_nop 1
    v_max_f32_dpp v4, v4, v4 row_ror:8 row_mask:0xf bank_mask:0xf
    s_nop 1
    v_max_f32_dpp v4, v4, v4 row_ror:4 row_mask:0xf bank_mask:0xf
    s_nop 1
    v_max_f32_dpp v4, v4, v4 row_ror:2 row_mask:0xf bank_mask:0xf
    s_nop 1
    v_max_f32_dpp v4, v4, v4 row_ror:1 row_mask:0xf bank_mask:0xf
    v_mul_f32 v5, s43, v3
    v_mul_f32 v6, s43, v4
    v_fma_f32 v36, v36, s43, -v5
    v_fma_f32 v37, v37, s43, -v6
    v_fma_f32 v40, v40, s43, -v5
    v_fma_f32 v41, v41, s43, -v6
    v_fma_f32 v44, v44, s43, -v5
    v_fma_f32 v45, v45, s43, -v6
    v_fma_f32 v48, v48, s43, -v5
    v_fma_f32 v49, v49, s43, -v6
    v_fma_f32 v52, v52, s43, -v5
    v_fma_f32 v53, v53, s43, -v6
    v_fma_f32 v56, v56, s43, -v5
    v_fma_f32 v57, v57, s43, -v6
    v_exp_f32 v36, v36
    v_exp_f32 v37, v37
    v_exp_f32 v40, v40
    v_exp_f32 v41, v41
    v_exp_f32 v44, v44
    v_exp_f32 v45, v45
    v_exp_f32 v48, v48
    v_exp_f32 v49, v49
    v_exp_f32 v52, v52
    v_exp_f32 v53, v53
    v_exp_f32 v56, v56
    v_exp_f32 v57, v57
    v_add_u32 v6, 16384, v60
    s_waitcnt vmcnt(7)
    global_load_dwordx4 v[128:131], v6, s[12:13] nt
    v_add_u32 v6, 17408, v60
    s_waitcnt vmcnt(7)
    global_load_dwordx4 v[132:135], v6, s[12:13] nt
    v_add_u32 v6, 18432, v60
    s_waitcnt vmcnt(7)
    global_load_dwordx4 v[136:139], v6, s[12:13] nt
    v_add_u32 v6, 19456, v60
    s_waitcnt vmcnt(7)
    global_load_dwordx4 v[140:143], v6, s[12:13] nt
    v_cvt_pk_bf16_f32 v38, v36, v37
    v_cvt_pk_bf16_f32 v42, v40, v41
    v_cvt_pk_bf16_f32 v46, v44, v45
    v_cvt_pk_bf16_f32 v50, v48, v49
    v_cvt_pk_bf16_f32 v54, v52, v53
    v_cvt_pk_bf16_f32 v58, v56, v57
    v_add_f32 v7, v36, v40
    v_add_f32 v7, v7, v44
    v_add_f32 v7, v7, v48
    v_add_f32 v7, v7, v52
    v_add_f32 v7, v7, v56
    s_nop 1
    v_add_f32_dpp v7, v7, v7 row_ror:8 row_mask:0xf bank_mask:0xf
    s_nop 1
    v_add_f32_dpp v7, v7, v7 row_ror:4 row_mask:0xf bank_mask:0xf
    s_nop 1
    v_add_f32_dpp v7, v7, v7 row_ror:2 row_mask:0xf bank_mask:0xf
    s_nop 1
    v_add_f32_dpp v7, v7, v7 row_ror:1 row_mask:0xf bank_mask:0xf
    v_add_f32 v8, v37, v41
    v_add_f32 v8, v8, v45
    v_add_f32 v8, v8, v49
    v_add_f32 v8, v8, v53
    v_add_f32 v8, v8, v57
    s_nop 1
    v_add_f32_dpp v8, v8, v8 row_ror:8 row_mask:0xf bank_mask:0xf
    s_nop 1
    v_add_f32_dpp v8, v8, v8 row_ror:4 row_mask:0xf bank_mask:0xf
    s_nop 1
    v_add_f32_dpp v8, v8, v8 row_ror:2 row_mask:0xf bank_mask:0xf
    s_nop 1
    v_add_f32_dpp v8, v8, v8 row_ror:1 row_mask:0xf bank_mask:0xf
    s_mul_i32 s50, s40, 384
    v_and_b32 v5, 3, v9
    v_mul_u32_u24 v5, 48, v5
    v_lshrrev_b32 v6, 2, v9
    v_lshl_add_u32 v5, v6, 1, v5
    v_add_u32 v5, s50, v5
    s_mov_b64 exec, 0xffff
    ds_write_b16 v5, v38 offset:17408
    ds_write_b16_d16_hi v5, v38 offset:17600
    ds_write_b16 v5, v42 offset:17416
    ds_write_b16_d16_hi v5, v42 offset:17608
    ds_write_b16 v5, v46 offset:17424
    ds_write_b16_d16_hi v5, v46 offset:17616
    ds_write_b16 v5, v50 offset:17432
    ds_write_b16_d16_hi v5, v50 offset:17624
    ds_write_b16 v5, v54 offset:17440
    ds_write_b16_d16_hi v5, v54 offset:17632
    ds_write_b16 v5, v58 offset:17448
    ds_write_b16_d16_hi v5, v58 offset:17640
    s_mov_b64 exec, -1
    v_add_u32 v6, 0, v61
    s_waitcnt vmcnt(7)
    global_load_dwordx4 v[144:147], v6, s[12:13] nt
    v_add_u32 v6, 1024, v61
    s_waitcnt vmcnt(7)
    global_load_dwordx4 v[148:151], v6, s[12:13] nt
    v_add_u32 v6, 2048, v61
    s_waitcnt vmcnt(7)
    global_load_dwordx4 v[152:155], v6, s[12:13] nt
    v_add_u32 v6, 3072, v61
    s_waitcnt vmcnt(7)
    global_load_dwordx4 v[156:159], v6, s[12:13] nt
    s_lshl_b32 s50, s44, 8
    s_lshl_b32 s51, s40, 5
    s_add_u32 s50, s50, s51
    s_mul_i32 s50, s50, 1152
    s_mul_i32 s51, s46, 192
    s_add_u32 s50, s50, s51
    v_mul_u32_u24 v5, 2304, v10
    v_mul_u32_u24 v6, 12, v9
    v_add3_u32 v5, v5, v6, s50
    v_add_u32 v6, 0, v5
    global_load_dwordx3 v[160:162], v6, s[16:17]
    v_add_u32 v6, 1152, v5
    global_load_dwordx3 v[164:166], v6, s[16:17]
    v_add_u32 v6, 9216, v5
    global_load_dwordx3 v[168:170], v6, s[16:17]
    v_add_u32 v6, 10368, v5
    global_load_dwordx3 v[172:174], v6, s[16:17]
    v_add_u32 v6, 18432, v5
    global_load_dwordx3 v[176:178], v6, s[16:17]
    v_add_u32 v6, 19584, v5
    global_load_dwordx3 v[180:182], v6, s[16:17]
    v_add_u32 v6, 27648, v5
    global_load_dwordx3 v[184:186], v6, s[16:17]
    v_add_u32 v6, 28800, v5
    global_load_dwordx3 v[188:190], v6, s[16:17]
    s_mov_b64 exec, 1
    v_mov_b32 v60, v3
    v_mov_b32 v61, v7
    v_mov_b32 v62, v4
    v_mov_b32 v63, v8
    s_lshl_b32 s50, s40, 4
    v_mov_b32 v3, s50
    ds_write_b128 v3, v[60:63] offset:20480
    s_mov_b64 exec, -1
    s_waitcnt lgkmcnt(0)
    s_mul_i32 s50, s40, 384
    v_mul_u32_u24 v5, 48, v10
    v_add_u32 v5, s50, v5
    ds_read_b128 v[36:39], v5 offset:17408
    ds_read_b128 v[40:43], v5 offset:17424
    ds_read_b128 v[44:47], v5 offset:17440
    ds_read_b128 v[48:51], v5 offset:17600
    ds_read_b128 v[52:55], v5 offset:17616
    ds_read_b128 v[56:59], v5 offset:17632
    v_mov_b32 v12, 0
    v_mov_b32 v13, 0
    v_mov_b32 v14, 0
    v_mov_b32 v15, 0
    v_mov_b32 v16, 0
    v_mov_b32 v17, 0
    v_mov_b32 v18, 0
    v_mov_b32 v19, 0
    v_mov_b32 v20, 0
    v_mov_b32 v21, 0
    v_mov_b32 v22, 0
    v_mov_b32 v23, 0
    v_mov_b32 v24, 0
    v_mov_b32 v25, 0
    v_mov_b32 v26, 0
    v_mov_b32 v27, 0
    s_waitcnt lgkmcnt(0)
    s_waitcnt vmcnt(30)
    v_perm_b32 v7, v68, v64, s41
    v_perm_b32 v8, v68, v64, s42
    v_dot2_f32_bf16 v12, v7, v36, v12
    v_dot2_f32_bf16 v13, v8, v36, v13
    v_dot2_f32_bf16 v20, v7, v48, v20
    v_dot2_f32_bf16 v21, v8, v48, v21
    v_perm_b32 v7, v69, v65, s41
    v_perm_b32 v8, v69, v65, s42
    v_dot2_f32_bf16 v14, v7, v36, v14
    v_dot2_f32_bf16 v15, v8, v36, v15
    v_dot2_f32_bf16 v22, v7, v48, v22
    v_dot2_f32_bf16 v23, v8, v48, v23
    v_perm_b32 v7, v70, v66, s41
    v_perm_b32 v8, v70, v66, s42
    v_dot2_f32_bf16 v16, v7, v36, v16
    v_dot2_f32_bf16 v17, v8, v36, v17
    v_dot2_f32_bf16 v24, v7, v48, v24
    v_dot2_f32_bf16 v25, v8, v48, v25
    v_perm_b32 v7, v71, v67, s41
    v_perm_b32 v8, v71, v67, s42
    v_dot2_f32_bf16 v18, v7, v36, v18
    v_dot2_f32_bf16 v19, v8, v36, v19
    v_dot2_f32_bf16 v26, v7, v48, v26
    v_dot2_f32_bf16 v27, v8, v48, v27
    s_waitcnt vmcnt(28)
    v_perm_b32 v7, v76, v72, s41
    v_perm_b32 v8, v76, v72, s42
    v_dot2_f32_bf16 v12, v7, v37, v12
    v_dot2_f32_bf16 v13, v8, v37, v13
    v_dot2_f32_bf16 v20, v7, v49, v20
    v_dot2_f32_bf16 v21, v8, v49, v21
    v_perm_b32 v7, v77, v73, s41
    v_perm_b32 v8, v77, v73, s42
    v_dot2_f32_bf16 v14, v7, v37, v14
    v_dot2_f32_bf16 v15, v8, v37, v15
    v_dot2_f32_bf16 v22, v7, v49, v22
    v_dot2_f32_bf16 v23, v8, v49, v23
    v_perm_b32 v7, v78, v74, s41
    v_perm_b32 v8, v78, v74, s42
    v_dot2_f32_bf16 v16, v7, v37, v16
    v_dot2_f32_bf16 v17, v8, v37, v17
    v_dot2_f32_bf16 v24, v7, v49, v24
    v_dot2_f32_bf16 v25, v8, v49, v25
    v_perm_b32 v7, v79, v75, s41
    v_perm_b32 v8, v79, v75, s42
    v_dot2_f32_bf16 v18, v7, v37, v18
    v_dot2_f32_bf16 v19, v8, v37, v19
    v_dot2_f32_bf16 v26, v7, v49, v26
    v_dot2_f32_bf16 v27, v8, v49, v27
    s_waitcnt vmcnt(26)
    v_perm_b32 v7, v84, v80, s41
    v_perm_b32 v8, v84, v80, s42
    v_dot2_f32_bf16 v12, v7, v38, v12
    v_dot2_f32_bf16 v13, v8, v38, v13
    v_dot2_f32_bf16 v20, v7, v50, v20
    v_dot2_f32_bf16 v21, v8, v50, v21
    v_perm_b32 v7, v85, v81, s41
    v_perm_b32 v8, v85, v81, s42
    v_dot2_f32_bf16 v14, v7, v38, v14
    v_dot2_f32_bf16 v15, v8, v38, v15
    v_dot2_f32_bf16 v22, v7, v50, v22
    v_dot2_f32_bf16 v23, v8, v50, v23
    v_perm_b32 v7, v86, v82, s41
    v_perm_b32 v8, v86, v82, s42
    v_dot2_f32_bf16 v16, v7, v38, v16
    v_dot2_f32_bf16 v17, v8, v38, v17
    v_dot2_f32_bf16 v24, v7, v50, v24
    v_dot2_f32_bf16 v25, v8, v50, v25
    v_perm_b32 v7, v87, v83, s41
    v_perm_b32 v8, v87, v83, s42
    v_dot2_f32_bf16 v18, v7, v38, v18
    v_dot2_f32_bf16 v19, v8, v38, v19
    v_dot2_f32_bf16 v26, v7, v50, v26
    v_dot2_f32_bf16 v27, v8, v50, v27
    s_waitcnt vmcnt(24)
    v_perm_b32 v7, v92, v88, s41
    v_perm_b32 v8, v92, v88, s42
    v_dot2_f32_bf16 v12, v7, v39, v12
    v_dot2_f32_bf16 v13, v8, v39, v13
    v_dot2_f32_bf16 v20, v7, v51, v20
    v_dot2_f32_bf16 v21, v8, v51, v21
    v_perm_b32 v7, v93, v89, s41
    v_perm_b32 v8, v93, v89, s42
    v_dot2_f32_bf16 v14, v7, v39, v14
    v_dot2_f32_bf16 v15, v8, v39, v15
    v_dot2_f32_bf16 v22, v7, v51, v22
    v_dot2_f32_bf16 v23, v8, v51, v23
    v_perm_b32 v7, v94, v90, s41
    v_perm_b32 v8, v94, v90, s42
    v_dot2_f32_bf16 v16, v7, v39, v16
    v_dot2_f32_bf16 v17, v8, v39, v17
    v_dot2_f32_bf16 v24, v7, v51, v24
    v_dot2_f32_bf16 v25, v8, v51, v25
    v_perm_b32 v7, v95, v91, s41
    v_perm_b32 v8, v95, v91, s42
    v_dot2_f32_bf16 v18, v7, v39, v18
    v_dot2_f32_bf16 v19, v8, v39, v19
    v_dot2_f32_bf16 v26, v7, v51, v26
    v_dot2_f32_bf16 v27, v8, v51, v27
    s_waitcnt vmcnt(22)
    v_perm_b32 v7, v100, v96, s41
    v_perm_b32 v8, v100, v96, s42
    v_dot2_f32_bf16 v12, v7, v40, v12
    v_dot2_f32_bf16 v13, v8, v40, v13
    v_dot2_f32_bf16 v20, v7, v52, v20
    v_dot2_f32_bf16 v21, v8, v52, v21
    v_perm_b32 v7, v101, v97, s41
    v_perm_b32 v8, v101, v97, s42
    v_dot2_f32_bf16 v14, v7, v40, v14
    v_dot2_f32_bf16 v15, v8, v40, v15
    v_dot2_f32_bf16 v22, v7, v52, v22
    v_dot2_f32_bf16 v23, v8, v52, v23
    v_perm_b32 v7, v102, v98, s41
    v_perm_b32 v8, v102, v98, s42
    v_dot2_f32_bf16 v16, v7, v40, v16
    v_dot2_f32_bf16 v17, v8, v40, v17
    v_dot2_f32_bf16 v24, v7, v52, v24
    v_dot2_f32_bf16 v25, v8, v52, v25
    v_perm_b32 v7, v103, v99, s41
    v_perm_b32 v8, v103, v99, s42
    v_dot2_f32_bf16 v18, v7, v40, v18
    v_dot2_f32_bf16 v19, v8, v40, v19
    v_dot2_f32_bf16 v26, v7, v52, v26
    v_dot2_f32_bf16 v27, v8, v52, v27
    s_waitcnt vmcnt(20)
    v_perm_b32 v7, v108, v104, s41
    v_perm_b32 v8, v108, v104, s42
    v_dot2_f32_bf16 v12, v7, v41, v12
    v_dot2_f32_bf16 v13, v8, v41, v13
    v_dot2_f32_bf16 v20, v7, v53, v20
    v_dot2_f32_bf16 v21, v8, v53, v21
    v_perm_b32 v7, v109, v105, s41
    v_perm_b32 v8, v109, v105, s42
    v_dot2_f32_bf16 v14, v7, v41, v14
    v_dot2_f32_bf16 v15, v8, v41, v15
    v_dot2_f32_bf16 v22, v7, v53, v22
    v_dot2_f32_bf16 v23, v8, v53, v23
    v_perm_b32 v7, v110, v106, s41
    v_perm_b32 v8, v110, v106, s42
    v_dot2_f32_bf16 v16, v7, v41, v16
    v_dot2_f32_bf16 v17, v8, v41, v17
    v_dot2_f32_bf16 v24, v7, v53, v24
    v_dot2_f32_bf16 v25, v8, v53, v25
    v_perm_b32 v7, v111, v107, s41
    v_perm_b32 v8, v111, v107, s42
    v_dot2_f32_bf16 v18, v7, v41, v18
    v_dot2_f32_bf16 v19, v8, v41, v19
    v_dot2_f32_bf16 v26, v7, v53, v26
    v_dot2_f32_bf16 v27, v8, v53, v27
    s_waitcnt vmcnt(18)
    v_perm_b32 v7, v116, v112, s41
    v_perm_b32 v8, v116, v112, s42
    v_dot2_f32_bf16 v12, v7, v42, v12
    v_dot2_f32_bf16 v13, v8, v42, v13
    v_dot2_f32_bf16 v20, v7, v54, v20
    v_dot2_f32_bf16 v21, v8, v54, v21
    v_perm_b32 v7, v117, v113, s41
    v_perm_b32 v8, v117, v113, s42
    v_dot2_f32_bf16 v14, v7, v42, v14
    v_dot2_f32_bf16 v15, v8, v42, v15
    v_dot2_f32_bf16 v22, v7, v54, v22
    v_dot2_f32_bf16 v23, v8, v54, v23
    v_perm_b32 v7, v118, v114, s41
    v_perm_b32 v8, v118, v114, s42
    v_dot2_f32_bf16 v16, v7, v42, v16
    v_dot2_f32_bf16 v17, v8, v42, v17
    v_dot2_f32_bf16 v24, v7, v54, v24
    v_dot2_f32_bf16 v25, v8, v54, v25
    v_perm_b32 v7, v119, v115, s41
    v_perm_b32 v8, v119, v115, s42
    v_dot2_f32_bf16 v18, v7, v42, v18
    v_dot2_f32_bf16 v19, v8, v42, v19
    v_dot2_f32_bf16 v26, v7, v54, v26
    v_dot2_f32_bf16 v27, v8, v54, v27
    s_waitcnt vmcnt(16)
    v_perm_b32 v7, v124, v120, s41
    v_perm_b32 v8, v124, v120, s42
    v_dot2_f32_bf16 v12, v7, v43, v12
    v_dot2_f32_bf16 v13, v8, v43, v13
    v_dot2_f32_bf16 v20, v7, v55, v20
    v_dot2_f32_bf16 v21, v8, v55, v21
    v_perm_b32 v7, v125, v121, s41
    v_perm_b32 v8, v125, v121, s42
    v_dot2_f32_bf16 v14, v7, v43, v14
    v_dot2_f32_bf16 v15, v8, v43, v15
    v_dot2_f32_bf16 v22, v7, v55, v22
    v_dot2_f32_bf16 v23, v8, v55, v23
    v_perm_b32 v7, v126, v122, s41
    v_perm_b32 v8, v126, v122, s42
    v_dot2_f32_bf16 v16, v7, v43, v16
    v_dot2_f32_bf16 v17, v8, v43, v17
    v_dot2_f32_bf16 v24, v7, v55, v24
    v_dot2_f32_bf16 v25, v8, v55, v25
    v_perm_b32 v7, v127, v123, s41
    v_perm_b32 v8, v127, v123, s42
    v_dot2_f32_bf16 v18, v7, v43, v18
    v_dot2_f32_bf16 v19, v8, v43, v19
    v_dot2_f32_bf16 v26, v7, v55, v26
    v_dot2_f32_bf16 v27, v8, v55, v27
    s_waitcnt vmcnt(14)
    v_perm_b32 v7, v132, v128, s41
    v_perm_b32 v8, v132, v128, s42
    v_dot2_f32_bf16 v12, v7, v44, v12
    v_dot2_f32_bf16 v13, v8, v44, v13
    v_dot2_f32_bf16 v20, v7, v56, v20
    v_dot2_f32_bf16 v21, v8, v56, v21
    v_perm_b32 v7, v133, v129, s41
    v_perm_b32 v8, v133, v129, s42
    v_dot2_f32_bf16 v14, v7, v44, v14
    v_dot2_f32_bf16 v15, v8, v44, v15
    v_dot2_f32_bf16 v22, v7, v56, v22
    v_dot2_f32_bf16 v23, v8, v56, v23
    v_perm_b32 v7, v134, v130, s41
    v_perm_b32 v8, v134, v130, s42
    v_dot2_f32_bf16 v16, v7, v44, v16
    v_dot2_f32_bf16 v17, v8, v44, v17
    v_dot2_f32_bf16 v24, v7, v56, v24
    v_dot2_f32_bf16 v25, v8, v56, v25
    v_perm_b32 v7, v135, v131, s41
    v_perm_b32 v8, v135, v131, s42
    v_dot2_f32_bf16 v18, v7, v44, v18
    v_dot2_f32_bf16 v19, v8, v44, v19
    v_dot2_f32_bf16 v26, v7, v56, v26
    v_dot2_f32_bf16 v27, v8, v56, v27
    s_waitcnt vmcnt(12)
    v_perm_b32 v7, v140, v136, s41
    v_perm_b32 v8, v140, v136, s42
    v_dot2_f32_bf16 v12, v7, v45, v12
    v_dot2_f32_bf16 v13, v8, v45, v13
    v_dot2_f32_bf16 v20, v7, v57, v20
    v_dot2_f32_bf16 v21, v8, v57, v21
    v_perm_b32 v7, v141, v137, s41
    v_perm_b32 v8, v141, v137, s42
    v_dot2_f32_bf16 v14, v7, v45, v14
    v_dot2_f32_bf16 v15, v8, v45, v15
    v_dot2_f32_bf16 v22, v7, v57, v22
    v_dot2_f32_bf16 v23, v8, v57, v23
    v_perm_b32 v7, v142, v138, s41
    v_perm_b32 v8, v142, v138, s42
    v_dot2_f32_bf16 v16, v7, v45, v16
    v_dot2_f32_bf16 v17, v8, v45, v17
    v_dot2_f32_bf16 v24, v7, v57, v24
    v_dot2_f32_bf16 v25, v8, v57, v25
    v_perm_b32 v7, v143, v139, s41
    v_perm_b32 v8, v143, v139, s42
    v_dot2_f32_bf16 v18, v7, v45, v18
    v_dot2_f32_bf16 v19, v8, v45, v19
    v_dot2_f32_bf16 v26, v7, v57, v26
    v_dot2_f32_bf16 v27, v8, v57, v27
    s_waitcnt vmcnt(10)
    v_perm_b32 v7, v148, v144, s41
    v_perm_b32 v8, v148, v144, s42
    v_dot2_f32_bf16 v12, v7, v46, v12
    v_dot2_f32_bf16 v13, v8, v46, v13
    v_dot2_f32_bf16 v20, v7, v58, v20
    v_dot2_f32_bf16 v21, v8, v58, v21
    v_perm_b32 v7, v149, v145, s41
    v_perm_b32 v8, v149, v145, s42
    v_dot2_f32_bf16 v14, v7, v46, v14
    v_dot2_f32_bf16 v15, v8, v46, v15
    v_dot2_f32_bf16 v22, v7, v58, v22
    v_dot2_f32_bf16 v23, v8, v58, v23
    v_perm_b32 v7, v150, v146, s41
    v_perm_b32 v8, v150, v146, s42
    v_dot2_f32_bf16 v16, v7, v46, v16
    v_dot2_f32_bf16 v17, v8, v46, v17
    v_dot2_f32_bf16 v24, v7, v58, v24
    v_dot2_f32_bf16 v25, v8, v58, v25
    v_perm_b32 v7, v151, v147, s41
    v_perm_b32 v8, v151, v147, s42
    v_dot2_f32_bf16 v18, v7, v46, v18
    v_dot2_f32_bf16 v19, v8, v46, v19
    v_dot2_f32_bf16 v26, v7, v58, v26
    v_dot2_f32_bf16 v27, v8, v58, v27
    s_waitcnt vmcnt(8)
    v_perm_b32 v7, v156, v152, s41
    v_perm_b32 v8, v156, v152, s42
    v_dot2_f32_bf16 v12, v7, v47, v12
    v_dot2_f32_bf16 v13, v8, v47, v13
    v_dot2_f32_bf16 v20, v7, v59, v20
    v_dot2_f32_bf16 v21, v8, v59, v21
    v_perm_b32 v7, v157, v153, s41
    v_perm_b32 v8, v157, v153, s42
    v_dot2_f32_bf16 v14, v7, v47, v14
    v_dot2_f32_bf16 v15, v8, v47, v15
    v_dot2_f32_bf16 v22, v7, v59, v22
    v_dot2_f32_bf16 v23, v8, v59, v23
    v_perm_b32 v7, v158, v154, s41
    v_perm_b32 v8, v158, v154, s42
    v_dot2_f32_bf16 v16, v7, v47, v16
    v_dot2_f32_bf16 v17, v8, v47, v17
    v_dot2_f32_bf16 v24, v7, v59, v24
    v_dot2_f32_bf16 v25, v8, v59, v25
    v_perm_b32 v7, v159, v155, s41
    v_perm_b32 v8, v159, v155, s42
    v_dot2_f32_bf16 v18, v7, v47, v18
    v_dot2_f32_bf16 v19, v8, v47, v19
    v_dot2_f32_bf16 v26, v7, v59, v26
    v_dot2_f32_bf16 v27, v8, v59, v27
    s_lshl_b32 s50, s40, 12
    v_lshlrev_b32 v5, 10, v10
    v_lshl_add_u32 v5, v9, 5, v5
    v_add_u32 v5, s50, v5
    ds_write_b128 v5, v[12:15] offset:24576
    ds_write_b128 v5, v[16:19] offset:24592
    ds_write_b128 v5, v[20:23] offset:25088
    ds_write_b128 v5, v[24:27] offset:25104
    s_waitcnt lgkmcnt(0)
    s_barrier
    s_cmp_ge_u32 s40, 4
    s_cbranch_scc1 ARED_11
    v_lshrrev_b32 v3, 7, v0
    v_lshlrev_b32 v4, 3, v3
    ds_read_b64 v[36:37], v4 offset:20480
    ds_read_b64 v[38:39], v4 offset:20496
    ds_read_b64 v[40:41], v4 offset:20512
    ds_read_b64 v[42:43], v4 offset:20528
    ds_read_b64 v[44:45], v4 offset:20544
    ds_read_b64 v[46:47], v4 offset:20560
    ds_read_b64 v[48:49], v4 offset:20576
    ds_read_b64 v[50:51], v4 offset:20592
    v_lshlrev_b32 v5, 2, v0
    ds_read_b32 v64, v5 offset:24576
    ds_read_b32 v65, v5 offset:25600
    ds_read_b32 v66, v5 offset:26624
    ds_read_b32 v67, v5 offset:27648
    ds_read_b32 v68, v5 offset:28672
    ds_read_b32 v69, v5 offset:29696
    ds_read_b32 v70, v5 offset:30720
    ds_read_b32 v71, v5 offset:31744
    ds_read_b32 v72, v5 offset:32768
    ds_read_b32 v73, v5 offset:33792
    ds_read_b32 v74, v5 offset:34816
    ds_read_b32 v75, v5 offset:35840
    ds_read_b32 v76, v5 offset:36864
    ds_read_b32 v77, v5 offset:37888
    ds_read_b32 v78, v5 offset:38912
    ds_read_b32 v79, v5 offset:39936
    ds_read_b32 v80, v5 offset:40960
    ds_read_b32 v81, v5 offset:41984
    ds_read_b32 v82, v5 offset:43008
    ds_read_b32 v83, v5 offset:44032
    ds_read_b32 v84, v5 offset:45056
    ds_read_b32 v85, v5 offset:46080
    ds_read_b32 v86, v5 offset:47104
    ds_read_b32 v87, v5 offset:48128
    ds_read_b32 v88, v5 offset:49152
    ds_read_b32 v89, v5 offset:50176
    ds_read_b32 v90, v5 offset:51200
    ds_read_b32 v91, v5 offset:52224
    ds_read_b32 v92, v5 offset:53248
    ds_read_b32 v93, v5 offset:54272
    ds_read_b32 v94, v5 offset:55296
    ds_read_b32 v95, v5 offset:56320
    s_waitcnt lgkmcnt(0)
    v_max3_f32 v6, v36, v38, v40
    v_max3_f32 v6, v6, v42, v44
    v_max3_f32 v6, v6, v46, v48
    v_max_f32 v6, v6, v50
    v_sub_f32 v36, v36, v6
    v_mul_f32 v36, s43, v36
    v_exp_f32 v36, v36
    v_sub_f32 v38, v38, v6
    v_mul_f32 v38, s43, v38
    v_exp_f32 v38, v38
    v_sub_f32 v40, v40, v6
    v_mul_f32 v40, s43, v40
    v_exp_f32 v40, v40
    v_sub_f32 v42, v42, v6
    v_mul_f32 v42, s43, v42
    v_exp_f32 v42, v42
    v_sub_f32 v44, v44, v6
    v_mul_f32 v44, s43, v44
    v_exp_f32 v44, v44
    v_sub_f32 v46, v46, v6
    v_mul_f32 v46, s43, v46
    v_exp_f32 v46, v46
    v_sub_f32 v48, v48, v6
    v_mul_f32 v48, s43, v48
    v_exp_f32 v48, v48
    v_sub_f32 v50, v50, v6
    v_mul_f32 v50, s43, v50
    v_exp_f32 v50, v50
    v_mov_b32 v7, 0
    v_mov_b32 v8, 0
    v_fmac_f32 v7, v36, v37
    v_add_f32 v64, v64, v65
    v_add_f32 v66, v66, v67
    v_add_f32 v64, v64, v66
    v_fmac_f32 v8, v36, v64
    v_fmac_f32 v7, v38, v39
    v_add_f32 v68, v68, v69
    v_add_f32 v70, v70, v71
    v_add_f32 v68, v68, v70
    v_fmac_f32 v8, v38, v68
    v_fmac_f32 v7, v40, v41
    v_add_f32 v72, v72, v73
    v_add_f32 v74, v74, v75
    v_add_f32 v72, v72, v74
    v_fmac_f32 v8, v40, v72
    v_fmac_f32 v7, v42, v43
    v_add_f32 v76, v76, v77
    v_add_f32 v78, v78, v79
    v_add_f32 v76, v76, v78
    v_fmac_f32 v8, v42, v76
    v_fmac_f32 v7, v44, v45
    v_add_f32 v80, v80, v81
    v_add_f32 v82, v82, v83
    v_add_f32 v80, v80, v82
    v_fmac_f32 v8, v44, v80
    v_fmac_f32 v7, v46, v47
    v_add_f32 v84, v84, v85
    v_add_f32 v86, v86, v87
    v_add_f32 v84, v84, v86
    v_fmac_f32 v8, v46, v84
    v_fmac_f32 v7, v48, v49
    v_add_f32 v88, v88, v89
    v_add_f32 v90, v90, v91
    v_add_f32 v88, v88, v90
    v_fmac_f32 v8, v48, v88
    v_fmac_f32 v7, v50, v51
    v_add_f32 v92, v92, v93
    v_add_f32 v94, v94, v95
    v_add_f32 v92, v92, v94
    v_fmac_f32 v8, v50, v92
    s_mul_i32 s50, s47, 6
    s_add_u32 s50, s50, s46
    s_lshl_b32 s51, s50, 10
    s_add_u32 s51, s51, 0x18000
    v_add_u32 v5, s51, v5
    global_store_dword v5, v8, s[36:37] sc1
    s_lshl_b32 s51, s50, 4
    s_add_u32 s51, s51, 0x14000
    v_add_u32 v4, s51, v4
    v_and_b32 v3, 127, v0
    v_cmp_eq_u32 vcc, 0, v3
    s_and_saveexec_b64 s[58:59], vcc
    s_cbranch_execz ASTZ_12
    global_store_dwordx2 v4, v[6:7], s[36:37] sc1
ASTZ_12:
    s_mov_b64 exec, s[58:59]
ARED_11:
    s_waitcnt vmcnt(0)
    s_barrier
    s_cmp_lg_u32 s40, 0
    s_cbranch_scc1 AFL_13
    s_lshl_b32 s51, s47, 7
    s_add_u32 s51, s51, 0x381000
    s_lshl_b32 s50, s46, 2
    s_add_u32 s50, s50, s51
    v_mov_b32 v5, s50
    v_mov_b32 v6, s92
    s_mov_b64 exec, 0x1
    global_store_dword v5, v6, s[36:37] sc1
    s_mov_b64 exec, -1
    v_lshl_add_u32 v5, v2, 2, s51
    s_mov_b32 s51, 0
    s_mov_b64 exec, 0x3f
POLL_14:
    global_load_dword v6, v5, s[36:37] sc1
    s_waitcnt vmcnt(0)
    v_cmp_ne_u32 vcc, s92, v6
    s_nop 1
    s_cmp_eq_u64 vcc, 0
    s_cbranch_scc1 POLLX_15
    s_add_u32 s51, s51, 1
    s_cmp_gt_u32 s51, 1048576
    s_cbranch_scc1 POLLX_15
    s_sleep 2
    s_branch POLL_14
POLLX_15:
    s_mov_b64 exec, -1
AFL_13:
    s_barrier
    s_cmp_ge_u32 s40, 4
    s_cbranch_scc1 ACMB_16
    s_mul_i32 s50, s47, 6
    s_lshl_b32 s51, s50, 10
    s_add_u32 s51, s51, 0x18000
    v_lshl_add_u32 v5, v0, 2, s51
    v_add_u32 v6, 0, v5
    global_load_dword v48, v6, s[36:37] sc1
    v_add_u32 v6, 1024, v5
    global_load_dword v49, v6, s[36:37] sc1
    v_add_u32 v6, 2048, v5
    global_load_dword v50, v6, s[36:37] sc1
    v_add_u32 v6, 3072, v5
    global_load_dword v51, v6, s[36:37] sc1
    v_add_u32 v6, 4096, v5
    global_load_dword v52, v6, s[36:37] sc1
    v_add_u32 v6, 5120, v5
    global_load_dword v53, v6, s[36:37] sc1
    s_lshl_b32 s51, s50, 4
    s_add_u32 s51, s51, 0x14000
    v_lshrrev_b32 v3, 7, v0
    v_lshl_add_u32 v4, v3, 3, s51
    global_load_dwordx2 v[36:37], v4, s[36:37] offset:0 sc1
    global_load_dwordx2 v[38:39], v4, s[36:37] offset:16 sc1
    global_load_dwordx2 v[40:41], v4, s[36:37] offset:32 sc1
    global_load_dwordx2 v[42:43], v4, s[36:37] offset:48 sc1
    global_load_dwordx2 v[44:45], v4, s[36:37] offset:64 sc1
    global_load_dwordx2 v[46:47], v4, s[36:37] offset:80 sc1
    s_waitcnt vmcnt(0)
    v_max3_f32 v6, v36, v38, v40
    v_max3_f32 v6, v6, v42, v44
    v_max_f32 v6, v6, v46
    v_sub_f32 v36, v36, v6
    v_mul_f32 v36, s43, v36
    v_exp_f32 v36, v36
    v_sub_f32 v38, v38, v6
    v_mul_f32 v38, s43, v38
    v_exp_f32 v38, v38
    v_sub_f32 v40, v40, v6
    v_mul_f32 v40, s43, v40
    v_exp_f32 v40, v40
    v_sub_f32 v42, v42, v6
    v_mul_f32 v42, s43, v42
    v_exp_f32 v42, v42
    v_sub_f32 v44, v44, v6
    v_mul_f32 v44, s43, v44
    v_exp_f32 v44, v44
    v_sub_f32 v46, v46, v6
    v_mul_f32 v46, s43, v46
    v_exp_f32 v46, v46
    v_mov_b32 v7, 0
    v_mov_b32 v8, 0
    v_fmac_f32 v7, v36, v37
    v_fmac_f32 v8, v36, v48
    v_fmac_f32 v7, v38, v39
    v_fmac_f32 v8, v38, v49
    v_fmac_f32 v7, v40, v41
    v_fmac_f32 v8, v40, v50
    v_fmac_f32 v7, v42, v43
    v_fmac_f32 v8, v42, v51
    v_fmac_f32 v7, v44, v45
    v_fmac_f32 v8, v44, v52
    v_fmac_f32 v7, v46, v47
    v_fmac_f32 v8, v46, v53
    v_rcp_f32 v7, v7
    s_nop 0
    v_mul_f32 v8, v8, v7
    v_cvt_pk_bf16_f32 v6, v8, v8
    v_lshlrev_b32 v5, 1, v0
    ds_write_b16 v5, v6 offset:57344
ACMB_16:
    s_waitcnt lgkmcnt(0)
    s_barrier
    s_lshl_b32 s50, s40, 6
    v_lshl_add_u32 v5, v10, 2, s50
    ds_read_b32 v36, v5 offset:57344
    ds_read_b32 v37, v5 offset:57360
    ds_read_b32 v38, v5 offset:57376
    ds_read_b32 v39, v5 offset:57392
    v_mov_b32 v12, 0
    v_mov_b32 v13, 0
    v_mov_b32 v14, 0
    v_mov_b32 v15, 0
    v_mov_b32 v16, 0
    v_mov_b32 v17, 0
    s_waitcnt lgkmcnt(0)
    v_perm_b32 v7, v164, v160, s41
    v_perm_b32 v8, v164, v160, s42
    v_dot2_f32_bf16 v12, v7, v36, v12
    v_dot2_f32_bf16 v13, v8, v36, v13
    v_perm_b32 v7, v165, v161, s41
    v_perm_b32 v8, v165, v161, s42
    v_dot2_f32_bf16 v14, v7, v36, v14
    v_dot2_f32_bf16 v15, v8, v36, v15
    v_perm_b32 v7, v166, v162, s41
    v_perm_b32 v8, v166, v162, s42
    v_dot2_f32_bf16 v16, v7, v36, v16
    v_dot2_f32_bf16 v17, v8, v36, v17
    v_perm_b32 v7, v172, v168, s41
    v_perm_b32 v8, v172, v168, s42
    v_dot2_f32_bf16 v12, v7, v37, v12
    v_dot2_f32_bf16 v13, v8, v37, v13
    v_perm_b32 v7, v173, v169, s41
    v_perm_b32 v8, v173, v169, s42
    v_dot2_f32_bf16 v14, v7, v37, v14
    v_dot2_f32_bf16 v15, v8, v37, v15
    v_perm_b32 v7, v174, v170, s41
    v_perm_b32 v8, v174, v170, s42
    v_dot2_f32_bf16 v16, v7, v37, v16
    v_dot2_f32_bf16 v17, v8, v37, v17
    v_perm_b32 v7, v180, v176, s41
    v_perm_b32 v8, v180, v176, s42
    v_dot2_f32_bf16 v12, v7, v38, v12
    v_dot2_f32_bf16 v13, v8, v38, v13
    v_perm_b32 v7, v181, v177, s41
    v_perm_b32 v8, v181, v177, s42
    v_dot2_f32_bf16 v14, v7, v38, v14
    v_dot2_f32_bf16 v15, v8, v38, v15
    v_perm_b32 v7, v182, v178, s41
    v_perm_b32 v8, v182, v178, s42
    v_dot2_f32_bf16 v16, v7, v38, v16
    v_dot2_f32_bf16 v17, v8, v38, v17
    v_perm_b32 v7, v188, v184, s41
    v_perm_b32 v8, v188, v184, s42
    v_dot2_f32_bf16 v12, v7, v39, v12
    v_dot2_f32_bf16 v13, v8, v39, v13
    v_perm_b32 v7, v189, v185, s41
    v_perm_b32 v8, v189, v185, s42
    v_dot2_f32_bf16 v14, v7, v39, v14
    v_dot2_f32_bf16 v15, v8, v39, v15
    v_perm_b32 v7, v190, v186, s41
    v_perm_b32 v8, v190, v186, s42
    v_dot2_f32_bf16 v16, v7, v39, v16
    v_dot2_f32_bf16 v17, v8, v39, v17
    s_mul_i32 s50, s40, 1536
    v_mul_u32_u24 v5, 384, v10
    v_mul_u32_u24 v6, 24, v9
    v_add3_u32 v5, v5, v6, s50
    ds_write_b64 v5, v[12:13] offset:0
    ds_write_b64 v5, v[14:15] offset:8
    ds_write_b64 v5, v[16:17] offset:16
    s_waitcnt lgkmcnt(0)
    s_barrier
    v_cmp_gt_u32 vcc, 96, v0
    s_and_saveexec_b64 s[58:59], vcc
    s_cbranch_execz AY_17
    v_lshlrev_b32 v5, 2, v0
    ds_read_b32 v64, v5 offset:0
    ds_read_b32 v65, v5 offset:384
    ds_read_b32 v66, v5 offset:768
    ds_read_b32 v67, v5 offset:1152
    ds_read_b32 v68, v5 offset:1536
    ds_read_b32 v69, v5 offset:1920
    ds_read_b32 v70, v5 offset:2304
    ds_read_b32 v71, v5 offset:2688
    ds_read_b32 v72, v5 offset:3072
    ds_read_b32 v73, v5 offset:3456
    ds_read_b32 v74, v5 offset:3840
    ds_read_b32 v75, v5 offset:4224
    ds_read_b32 v76, v5 offset:4608
    ds_read_b32 v77, v5 offset:4992
    ds_read_b32 v78, v5 offset:5376
    ds_read_b32 v79, v5 offset:5760
    ds_read_b32 v80, v5 offset:6144
    ds_read_b32 v81, v5 offset:6528
    ds_read_b32 v82, v5 offset:6912
    ds_read_b32 v83, v5 offset:7296
    ds_read_b32 v84, v5 offset:7680
    ds_read_b32 v85, v5 offset:8064
    ds_read_b32 v86, v5 offset:8448
    ds_read_b32 v87, v5 offset:8832
    ds_read_b32 v88, v5 offset:9216
    ds_read_b32 v89, v5 offset:9600
    ds_read_b32 v90, v5 offset:9984
    ds_read_b32 v91, v5 offset:10368
    ds_read_b32 v92, v5 offset:10752
    ds_read_b32 v93, v5 offset:11136
    ds_read_b32 v94, v5 offset:11520
    ds_read_b32 v95, v5 offset:11904
    s_waitcnt lgkmcnt(0)
    v_add_f32 v64, v64, v80
    v_add_f32 v65, v65, v81
    v_add_f32 v66, v66, v82
    v_add_f32 v67, v67, v83
    v_add_f32 v68, v68, v84
    v_add_f32 v69, v69, v85
    v_add_f32 v70, v70, v86
    v_add_f32 v71, v71, v87
    v_add_f32 v72, v72, v88
    v_add_f32 v73, v73, v89
    v_add_f32 v74, v74, v90
    v_add_f32 v75, v75, v91
    v_add_f32 v76, v76, v92
    v_add_f32 v77, v77, v93
    v_add_f32 v78, v78, v94
    v_add_f32 v79, v79, v95
    v_add_f32 v64, v64, v72
    v_add_f32 v65, v65, v73
    v_add_f32 v66, v66, v74
    v_add_f32 v67, v67, v75
    v_add_f32 v68, v68, v76
    v_add_f32 v69, v69, v77
    v_add_f32 v70, v70, v78
    v_add_f32 v71, v71, v79
    v_add_f32 v64, v64, v68
    v_add_f32 v65, v65, v69
    v_add_f32 v66, v66, v70
    v_add_f32 v67, v67, v71
    v_add_f32 v64, v64, v66
    v_add_f32 v65, v65, v67
    v_add_f32 v64, v64, v65
    s_mul_i32 s50, s47, 2304
    s_mul_i32 s51, s46, 384
    s_add_u32 s50, s50, s51
    s_add_u32 s50, s50, 0x48000
    v_add_u32 v5, s50, v5
    global_store_dword v5, v64, s[36:37] sc1
AY_17:
    s_mov_b64 exec, s[58:59]
    s_waitcnt vmcnt(0)
    s_barrier
    s_cmp_lg_u32 s40, 0
    s_cbranch_scc1 AFL2_18
    s_mul_i32 s50, s45, 6
    s_add_u32 s50, s50, s46
    s_lshl_b32 s50, s50, 7
    s_lshl_b32 s51, s44, 2
    s_add_u32 s50, s50, s51
    s_add_u32 s50, s50, 0x382000
    v_mov_b32 v5, s50
    v_mov_b32 v6, s92
    s_mov_b64 exec, 0x1
    global_store_dword v5, v6, s[36:37] sc1
    s_mov_b64 exec, -1
AFL2_18:
    s_cmp_lg_u32 s44, 0
    s_cbranch_scc1 L_A_END
    s_cmp_lg_u32 s40, 0
    s_cbranch_scc1 FIN_19
    s_mul_i32 s50, s45, 1152
    v_lshl_add_u32 v5, v2, 1, s50
    v_lshlrev_b32 v6, 1, v2
    global_load_ushort v36, v5, s[8:9] offset:0
    global_load_ushort v45, v6, s[30:31] offset:0
    global_load_ushort v37, v5, s[8:9] offset:128
    global_load_ushort v46, v6, s[30:31] offset:128
    global_load_ushort v38, v5, s[8:9] offset:256
    global_load_ushort v47, v6, s[30:31] offset:256
    global_load_ushort v39, v5, s[8:9] offset:384
    global_load_ushort v48, v6, s[30:31] offset:384
    global_load_ushort v40, v5, s[8:9] offset:512
    global_load_ushort v49, v6, s[30:31] offset:512
    global_load_ushort v41, v5, s[8:9] offset:640
    global_load_ushort v50, v6, s[30:31] offset:640
    global_load_ushort v42, v5, s[8:9] offset:768
    global_load_ushort v51, v6, s[30:31] offset:768
    global_load_ushort v43, v5, s[8:9] offset:896
    global_load_ushort v52, v6, s[30:31] offset:896
    global_load_ushort v44, v5, s[8:9] offset:1024
    global_load_ushort v53, v6, s[30:31] offset:1024
    s_waitcnt vmcnt(0)
    v_mov_b32 v7, 0
    v_lshlrev_b32 v36, 16, v36
    v_lshlrev_b32 v45, 16, v45
    v_mul_f32 v36, v36, v45
    v_cvt_pk_bf16_f32 v36, v36, v36
    v_lshlrev_b32 v36, 16, v36
    v_add_f32 v7, v7, v36
    v_lshlrev_b32 v37, 16, v37
    v_lshlrev_b32 v46, 16, v46
    v_mul_f32 v37, v37, v46
    v_cvt_pk_bf16_f32 v37, v37, v37
    v_lshlrev_b32 v37, 16, v37
    v_add_f32 v7, v7, v37
    v_lshlrev_b32 v38, 16, v38
    v_lshlrev_b32 v47, 16, v47
    v_mul_f32 v38, v38, v47
    v_cvt_pk_bf16_f32 v38, v38, v38
    v_lshlrev_b32 v38, 16, v38
    v_add_f32 v7, v7, v38
    v_lshlrev_b32 v39, 16, v39
    v_lshlrev_b32 v48, 16, v48
    v_mul_f32 v39, v39, v48
    v_cvt_pk_bf16_f32 v39, v39, v39
    v_lshlrev_b32 v39, 16, v39
    v_add_f32 v7, v7, v39
    v_lshlrev_b32 v40, 16, v40
    v_lshlrev_b32 v49, 16, v49
    v_mul_f32 v40, v40, v49
    v_cvt_pk_bf16_f32 v40, v40, v40
    v_lshlrev_b32 v40, 16, v40
    v_add_f32 v7, v7, v40
    v_lshlrev_b32 v41, 16, v41
    v_lshlrev_b32 v50, 16, v50
    v_mul_f32 v41, v41, v50
    v_cvt_pk_bf16_f32 v41, v41, v41
    v_lshlrev_b32 v41, 16, v41
    v_add_f32 v7, v7, v41
    v_lshlrev_b32 v42, 16, v42
    v_lshlrev_b32 v51, 16, v51
    v_mul_f32 v42, v42, v51
    v_cvt_pk_bf16_f32 v42, v42, v42
    v_lshlrev_b32 v42, 16, v42
    v_add_f32 v7, v7, v42
    v_lshlrev_b32 v43, 16, v43
    v_lshlrev_b32 v52, 16, v52
    v_mul_f32 v43, v43, v52
    v_cvt_pk_bf16_f32 v43, v43, v43
    v_lshlrev_b32 v43, 16, v43
    v_add_f32 v7, v7, v43
    v_lshlrev_b32 v44, 16, v44
    v_lshlrev_b32 v53, 16, v53
    v_mul_f32 v44, v44, v53
    v_cvt_pk_bf16_f32 v44, v44, v44
    v_lshlrev_b32 v44, 16, v44
    v_add_f32 v7, v7, v44
    s_nop 1
    v_add_f32_dpp v7, v7, v7 row_ror:8 row_mask:0xf bank_mask:0xf
    s_nop 1
    v_add_f32_dpp v7, v7, v7 row_ror:4 row_mask:0xf bank_mask:0xf
    s_nop 1
    v_add_f32_dpp v7, v7, v7 row_ror:2 row_mask:0xf bank_mask:0xf
    s_nop 1
    v_add_f32_dpp v7, v7, v7 row_ror:1 row_mask:0xf bank_mask:0xf
    s_nop 1
    v_mov_b32 v8, v7
    s_nop 1
    v_permlane16_swap_b32 v7, v8
    s_nop 1
    v_add_f32 v7, v7, v8
    v_mov_b32 v8, v7
    s_nop 1
    v_permlane32_swap_b32 v7, v8
    s_nop 1
    v_add_f32 v7, v7, v8
    v_cvt_pk_bf16_f32 v7, v7, v7
    v_lshlrev_b32 v7, 16, v7
    v_mul_f32 v7, 0xbfb8aa3b, v7
    v_exp_f32 v7, v7
    s_nop 0
    v_add_f32 v7, 1.0, v7
    v_rcp_f32 v7, v7
    s_nop 0
    v_cvt_pk_bf16_f32 v7, v7, v7
    v_lshlrev_b32 v7, 16, v7
    v_mov_b32 v5, 0
    ds_write_b32 v5, v7 offset:14336
    s_mul_i32 s50, s45, 6
    s_add_u32 s50, s50, s46
    s_lshl_b32 s52, s50, 7
    s_add_u32 s52, s52, 0x382000
    v_lshl_add_u32 v5, v2, 2, s52
    s_mov_b32 s51, 0
    s_mov_b64 exec, 0xffff
POLL_20:
    global_load_dword v6, v5, s[36:37] sc1
    s_waitcnt vmcnt(0)
    v_cmp_ne_u32 vcc, s92, v6
    s_nop 1
    s_cmp_eq_u64 vcc, 0
    s_cbranch_scc1 POLLX_21
    s_add_u32 s51, s51, 1
    s_cmp_gt_u32 s51, 1048576
    s_cbranch_scc1 POLLX_21
    s_sleep 2
    s_branch POLL_20
POLLX_21:
    s_mov_b64 exec, -1
    s_lshl_b32 s52, s50, 8
    s_add_u32 s52, s52, 0x386000
    v_lshl_add_u32 v5, v2, 2, s52
    s_mov_b32 s51, 0
POLL_22:
    global_load_dword v6, v5, s[36:37] sc1
    s_waitcnt vmcnt(0)
    v_cmp_ne_u32 vcc, s92, v6
    s_nop 1
    s_cmp_eq_u64 vcc, 0
    s_cbranch_scc1 POLLX_23
    s_add_u32 s51, s51, 1
    s_cmp_gt_u32 s51, 1048576
    s_cbranch_scc1 POLLX_23
    s_sleep 2
    s_branch POLL_22
POLLX_23:
    s_mov_b64 exec, -1
FIN_19:
    s_waitcnt lgkmcnt(0)
    s_barrier
    v_cmp_gt_u32 vcc, 480, v0
    s_and_saveexec_b64 s[58:59], vcc
    s_cbranch_execz FIN2_24
    v_mul_u32_u24 v3, 683, v0
    v_lshrrev_b32 v3, 16, v3
    v_mul_u32_u24 v4, 96, v3
    v_sub_u32 v4, v0, v4
    s_mul_i32 s50, s45, 36864
    s_add_u32 s50, s50, 0x48000
    s_mul_i32 s51, s45, 147456
    s_add_u32 s51, s51, 0x57000
    v_mul_u32_u24 v5, 36864, v3
    v_add_u32 v5, s51, v5
    v_mov_b32 v6, s50
    v_cmp_eq_u32 vcc, 0, v3
    s_nop 1
    v_cndmask_b32 v5, v5, v6, vcc
    s_mul_i32 s52, s46, 384
    v_lshl_add_u32 v5, v4, 2, v5
    v_add_u32 v5, s52, v5
    v_add_u32 v6, 0, v5
    global_load_dword v64, v6, s[36:37] sc1
    v_add_u32 v6, 2304, v5
    global_load_dword v65, v6, s[36:37] sc1
    v_add_u32 v6, 4608, v5
    global_load_dword v66, v6, s[36:37] sc1
    v_add_u32 v6, 6912, v5
    global_load_dword v67, v6, s[36:37] sc1
    v_add_u32 v6, 9216, v5
    global_load_dword v68, v6, s[36:37] sc1
    v_add_u32 v6, 11520, v5
    global_load_dword v69, v6, s[36:37] sc1
    v_add_u32 v6, 13824, v5
    global_load_dword v70, v6, s[36:37] sc1
    v_add_u32 v6, 16128, v5
    global_load_dword v71, v6, s[36:37] sc1
    v_add_u32 v6, 18432, v5
    global_load_dword v72, v6, s[36:37] sc1
    v_add_u32 v6, 20736, v5
    global_load_dword v73, v6, s[36:37] sc1
    v_add_u32 v6, 23040, v5
    global_load_dword v74, v6, s[36:37] sc1
    v_add_u32 v6, 25344, v5
    global_load_dword v75, v6, s[36:37] sc1
    v_add_u32 v6, 27648, v5
    global_load_dword v76, v6, s[36:37] sc1
    v_add_u32 v6, 29952, v5
    global_load_dword v77, v6, s[36:37] sc1
    v_add_u32 v6, 32256, v5
    global_load_dword v78, v6, s[36:37] sc1
    v_add_u32 v6, 34560, v5
    global_load_dword v79, v6, s[36:37] sc1
    s_waitcnt vmcnt(0)
    v_add_f32 v64, v64, v72
    v_add_f32 v65, v65, v73
    v_add_f32 v66, v66, v74
    v_add_f32 v67, v67, v75
    v_add_f32 v68, v68, v76
    v_add_f32 v69, v69, v77
    v_add_f32 v70, v70, v78
    v_add_f32 v71, v71, v79
    v_add_f32 v64, v64, v68
    v_add_f32 v65, v65, v69
    v_add_f32 v66, v66, v70
    v_add_f32 v67, v67, v71
    v_add_f32 v64, v64, v66
    v_add_f32 v65, v65, v67
    v_add_f32 v64, v64, v65
    v_lshlrev_b32 v5, 2, v0
    ds_write_b32 v5, v64 offset:12288
FIN2_24:
    s_mov_b64 exec, s[58:59]
    s_waitcnt lgkmcnt(0)
    s_barrier
    v_cmp_gt_u32 vcc, 96, v0
    s_and_saveexec_b64 s[58:59], vcc
    s_cbranch_execz L_A_END
    v_lshlrev_b32 v5, 2, v0
    ds_read_b32 v36, v5 offset:12288
    ds_read_b32 v37, v5 offset:12672
    ds_read_b32 v38, v5 offset:13056
    ds_read_b32 v39, v5 offset:13440
    ds_read_b32 v40, v5 offset:13824
    v_mov_b32 v6, 0
    ds_read_b32 v7, v6 offset:14336
    s_waitcnt lgkmcnt(0)
    v_add_f32 v37, v37, v38
    v_add_f32 v39, v39, v40
    v_add_f32 v37, v37, v39
    v_cvt_pk_bf16_f32 v8, v36, v37
    v_lshlrev_b32 v36, 16, v8
    v_and_b32 v37, 0xffff0000, v8
    v_sub_f32 v8, 1.0, v7
    v_mul_f32 v36, v7, v36
    v_cvt_pk_bf16_f32 v8, v8, v8
    v_lshlrev_b32 v8, 16, v8
    v_mul_f32 v37, v8, v37
    v_cvt_pk_bf16_f32 v8, v36, v37
    v_lshlrev_b32 v36, 16, v8
    v_and_b32 v37, 0xffff0000, v8
    v_add_f32 v8, v36, v37
    v_cvt_pk_bf16_f32 v8, v8, v8
    s_mul_i32 s50, s45, 1152
    s_mul_i32 s51, s46, 192
    s_add_u32 s50, s50, s51
    v_lshl_add_u32 v5, v0, 1, s50
    global_store_short v5, v8, s[32:33]
L_A_END:
    s_mov_b64 exec, -1
    s_branch L_END
L_ROLE_B:
    s_and_b32 s50, s2, 7
    s_lshr_b32 s51, s2, 3
    s_lshl_b32 s44, s50, 2
    s_lshr_b32 s52, s51, 1
    s_add_u32 s44, s44, s52
    s_and_b32 s45, s51, 1
    s_lshr_b32 s46, s2, 5
    s_and_b32 s47, s2, 31
    v_and_b32 v9, 15, v2
    v_lshrrev_b32 v10, 4, v2
    s_lshl_b32 s51, s44, 8
    s_lshl_b32 s50, s45, 8
    s_lshl_b32 s52, s40, 5
    s_add_u32 s50, s50, s52
    s_lshl_b32 s52, s50, 13
    s_add_u32 s52, s52, s51
    v_lshlrev_b32 v5, 13, v9
    v_lshl_add_u32 v5, v10, 4, v5
    v_add_u32 v5, s52, v5
    v_add_u32 v6, 0x0, v5
    global_load_dwordx4 v[136:139], v6, s[24:25] offset:0 nt
    global_load_dwordx4 v[140:143], v6, s[24:25] offset:64 nt
    global_load_dwordx4 v[144:147], v6, s[24:25] offset:128 nt
    global_load_dwordx4 v[148:151], v6, s[24:25] offset:192 nt
    v_add_u32 v6, 0x20000, v5
    global_load_dwordx4 v[152:155], v6, s[24:25] offset:0 nt
    global_load_dwordx4 v[156:159], v6, s[24:25] offset:64 nt
    global_load_dwordx4 v[160:163], v6, s[24:25] offset:128 nt
    global_load_dwordx4 v[164:167], v6, s[24:25] offset:192 nt
    s_lshl_b32 s50, s46, 12
    s_lshl_b32 s51, s47, 7
    s_add_u32 s50, s50, s51
    s_lshl_b32 s51, s40, 4
    s_add_u32 s50, s50, s51
    s_lshl_b32 s50, s50, 10
    v_lshl_add_u32 v5, v2, 4, s50
    global_load_dwordx4 v[168:171], v5, s[20:21] offset:0 nt
    global_load_dwordx4 v[172:175], v5, s[20:21] offset:1024 nt
    global_load_dwordx4 v[176:179], v5, s[20:21] offset:2048 nt
    global_load_dwordx4 v[180:183], v5, s[20:21] offset:3072 nt
    v_add_u32 v5, 4096, v5
    global_load_dwordx4 v[184:187], v5, s[20:21] offset:0 nt
    global_load_dwordx4 v[188:191], v5, s[20:21] offset:1024 nt
    global_load_dwordx4 v[192:195], v5, s[20:21] offset:2048 nt
    global_load_dwordx4 v[196:199], v5, s[20:21] offset:3072 nt
    v_add_u32 v5, 4096, v5
    global_load_dwordx4 v[200:203], v5, s[20:21] offset:0 nt
    global_load_dwordx4 v[204:207], v5, s[20:21] offset:1024 nt
    global_load_dwordx4 v[208:211], v5, s[20:21] offset:2048 nt
    global_load_dwordx4 v[212:215], v5, s[20:21] offset:3072 nt
    v_add_u32 v5, 4096, v5
    global_load_dwordx4 v[216:219], v5, s[20:21] offset:0 nt
    global_load_dwordx4 v[220:223], v5, s[20:21] offset:1024 nt
    global_load_dwordx4 v[224:227], v5, s[20:21] offset:2048 nt
    global_load_dwordx4 v[228:231], v5, s[20:21] offset:3072 nt
    s_cmp_lg_u32 s40, 0
    s_cbranch_scc1 BQ_25
    s_cmp_eq_u32 s2, 0
    s_cbranch_scc1 NX_26
    v_mov_b32 v5, 0
    s_mov_b32 s51, 0
NL_27:
    global_load_dword v6, v5, s[34:35] sc1
    s_waitcnt vmcnt(0)
    v_readfirstlane_b32 s92, v6
    s_nop 3
    s_cmp_lg_u32 s92, 0
    s_cbranch_scc1 NX_26
    s_add_u32 s51, s51, 1
    s_cmp_gt_u32 s51, 1048576
    s_cbranch_scc1 NX_26
    s_sleep 4
    s_branch NL_27
NX_26:
    s_lshl_b32 s50, s44, 7
    s_add_u32 s50, s50, 0x383000
    v_lshl_add_u32 v5, v2, 2, s50
    s_mov_b32 s51, 0
    s_mov_b64 exec, 0x3f
POLL_28:
    global_load_dword v6, v5, s[36:37] sc1
    s_waitcnt vmcnt(0)
    v_cmp_ne_u32 vcc, s92, v6
    s_nop 1
    s_cmp_eq_u64 vcc, 0
    s_cbranch_scc1 POLLX_29
    s_add_u32 s51, s51, 1
    s_cmp_gt_u32 s51, 1048576
    s_cbranch_scc1 POLLX_29
    s_sleep 2
    s_branch POLL_28
POLLX_29:
    s_mov_b64 exec, -1
    s_mul_i32 s50, s44, 6144
    s_add_u32 s50, s50, 0x3a0000
    v_lshl_add_u32 v5, v2, 4, s50
    v_add_u32 v6, 0, v5
    global_load_dwordx4 v[64:67], v6, s[36:37] sc1
    v_add_u32 v6, 1024, v5
    global_load_dwordx4 v[68:71], v6, s[36:37] sc1
    v_add_u32 v6, 2048, v5
    global_load_dwordx4 v[72:75], v6, s[36:37] sc1
    v_add_u32 v6, 3072, v5
    global_load_dwordx4 v[76:79], v6, s[36:37] sc1
    v_add_u32 v6, 4096, v5
    global_load_dwordx4 v[80:83], v6, s[36:37] sc1
    v_add_u32 v6, 5120, v5
    global_load_dwordx4 v[84:87], v6, s[36:37] sc1
    s_waitcnt vmcnt(0)
    v_add_f32 v64, v64, v68
    v_add_f32 v65, v65, v69
    v_add_f32 v66, v66, v70
    v_add_f32 v67, v67, v71
    v_add_f32 v64, v64, v72
    v_add_f32 v65, v65, v73
    v_add_f32 v66, v66, v74
    v_add_f32 v67, v67, v75
    v_add_f32 v64, v64, v76
    v_add_f32 v65, v65, v77
    v_add_f32 v66, v66, v78
    v_add_f32 v67, v67, v79
    v_add_f32 v64, v64, v80
    v_add_f32 v65, v65, v81
    v_add_f32 v66, v66, v82
    v_add_f32 v67, v67, v83
    v_add_f32 v64, v64, v84
    v_add_f32 v65, v65, v85
    v_add_f32 v66, v66, v86
    v_add_f32 v67, v67, v87
    v_cvt_pk_bf16_f32 v6, v64, v65
    v_cvt_pk_bf16_f32 v7, v66, v67
    v_lshlrev_b32 v5, 3, v2
    v_add_u32 v5, 131072, v5
    ds_write_b64 v5, v[6:7]
BQ_25:
    s_waitcnt lgkmcnt(0)
    s_barrier
    v_mov_b32 v48, 0
    v_mov_b32 v49, 0
    v_mov_b32 v50, 0
    v_mov_b32 v51, 0
    v_mov_b32 v52, 0
    v_mov_b32 v53, 0
    v_mov_b32 v54, 0
    v_mov_b32 v55, 0
    v_mov_b32 v56, 0
    v_mov_b32 v57, 0
    v_mov_b32 v58, 0
    v_mov_b32 v59, 0
    v_mov_b32 v60, 0
    v_mov_b32 v61, 0
    v_mov_b32 v62, 0
    v_mov_b32 v63, 0
    v_lshlrev_b32 v5, 8, v9
    v_lshl_add_u32 v5, v10, 4, v5
    v_add_u32 v5, 131072, v5
    v_cmp_gt_u32 vcc, 2, v9
    s_and_saveexec_b64 s[58:59], vcc
    ds_read_b128 v[48:51], v5 offset:0
    ds_read_b128 v[52:55], v5 offset:64
    ds_read_b128 v[56:59], v5 offset:128
    ds_read_b128 v[60:63], v5 offset:192
    s_mov_b64 exec, s[58:59]
    s_waitcnt vmcnt(16) lgkmcnt(0)
    v_mfma_f32_16x16x32_bf16 v[12:15], v[136:139], v[48:51], 0
    v_mfma_f32_16x16x32_bf16 v[12:15], v[140:143], v[52:55], v[12:15]
    v_mfma_f32_16x16x32_bf16 v[12:15], v[144:147], v[56:59], v[12:15]
    v_mfma_f32_16x16x32_bf16 v[12:15], v[148:151], v[60:63], v[12:15]
    v_mfma_f32_16x16x32_bf16 v[16:19], v[152:155], v[48:51], 0
    v_mfma_f32_16x16x32_bf16 v[16:19], v[156:159], v[52:55], v[16:19]
    v_mfma_f32_16x16x32_bf16 v[16:19], v[160:163], v[56:59], v[16:19]
    v_mfma_f32_16x16x32_bf16 v[16:19], v[164:167], v[60:63], v[16:19]
    s_nop 7
    s_nop 1
    s_lshl_b32 s50, s45, 8
    s_lshl_b32 s52, s40, 5
    s_add_u32 s50, s50, s52
    s_lshl_b32 s50, s50, 1
    s_lshl_b32 s51, s44, 10
    s_add_u32 s50, s50, s51
    v_lshlrev_b32 v5, 15, v9
    v_lshl_add_u32 v5, v10, 3, v5
    v_add_u32 v5, s50, v5
    v_cvt_pk_bf16_f32 v20, v12, v13
    v_cvt_pk_bf16_f32 v21, v14, v15
    v_cvt_pk_bf16_f32 v22, v16, v17
    v_cvt_pk_bf16_f32 v23, v18, v19
    v_cmp_gt_u32 vcc, 2, v9
    s_and_saveexec_b64 s[58:59], vcc
    global_store_dwordx2 v5, v[20:21], s[36:37] offset:0 sc1
    global_store_dwordx2 v5, v[22:23], s[36:37] offset:32 sc1
    s_mov_b64 exec, s[58:59]
    s_lshl_b32 s51, s40, 14
    v_xor_b32 v24, 0, v2
    v_lshl_add_u32 v24, v24, 4, s51
    v_xor_b32 v25, 2, v2
    v_lshl_add_u32 v25, v25, 4, s51
    v_xor_b32 v26, 4, v2
    v_lshl_add_u32 v26, v26, 4, s51
    v_xor_b32 v27, 6, v2
    v_lshl_add_u32 v27, v27, 4, s51
    v_xor_b32 v28, 8, v2
    v_lshl_add_u32 v28, v28, 4, s51
    v_xor_b32 v29, 10, v2
    v_lshl_add_u32 v29, v29, 4, s51
    v_xor_b32 v30, 12, v2
    v_lshl_add_u32 v30, v30, 4, s51
    v_xor_b32 v31, 14, v2
    v_lshl_add_u32 v31, v31, 4, s51
    s_waitcnt vmcnt(0)
    ds_write_b128 v24, v[168:171] offset:0
    ds_write_b128 v25, v[172:175] offset:1024
    ds_write_b128 v26, v[176:179] offset:2048
    ds_write_b128 v27, v[180:183] offset:3072
    ds_write_b128 v28, v[184:187] offset:4096
    ds_write_b128 v29, v[188:191] offset:5120
    ds_write_b128 v30, v[192:195] offset:6144
    ds_write_b128 v31, v[196:199] offset:7168
    ds_write_b128 v24, v[200:203] offset:8192
    ds_write_b128 v25, v[204:207] offset:9216
    ds_write_b128 v26, v[208:211] offset:10240
    ds_write_b128 v27, v[212:215] offset:11264
    ds_write_b128 v28, v[216:219] offset:12288
    ds_write_b128 v29, v[220:223] offset:13312
    ds_write_b128 v30, v[224:227] offset:14336
    ds_write_b128 v31, v[228:231] offset:15360
    s_waitcnt lgkmcnt(0)
    s_barrier
    s_cmp_lg_u32 s40, 0
    s_cbranch_scc1 B1F_30
    s_lshl_b32 s50, s2, 2
    s_add_u32 s50, s50, 0x384000
    v_lshl_add_u32 v5, v2, 8, s50
    v_mov_b32 v6, s92
    s_mov_b64 exec, 0xff
    global_store_dword v5, v6, s[36:37] sc1
    s_mov_b64 exec, -1
    s_and_b32 s50, s2, 7
    s_lshl_b32 s50, s50, 8
    s_add_u32 s50, s50, 0x384000
    v_lshl_add_u32 v5, v2, 2, s50
    s_mov_b32 s51, 0
POLL_32:
    global_load_dword v6, v5, s[36:37] sc1
    s_waitcnt vmcnt(0)
    v_cmp_ne_u32 vcc, s92, v6
    s_nop 1
    s_cmp_eq_u64 vcc, 0
    s_cbranch_scc1 POLLX_33
    s_add_u32 s51, s51, 1
    s_cmp_gt_u32 s51, 1048576
    s_cbranch_scc1 POLLX_33
    s_sleep 2
    s_branch POLL_32
POLLX_33:
    s_mov_b64 exec, -1
    s_branch B1G_31
B1F_30:
    v_lshrrev_b32 v3, 3, v2
    v_and_b32 v4, 7, v2
    v_lshrrev_b32 v5, 1, v3
    v_and_b32 v5, 3, v5
    v_lshlrev_b32 v5, 1, v5
    v_xor_b32 v4, v4, v5
    v_lshlrev_b32 v4, 4, v4
    v_lshl_add_u32 v4, v3, 13, v4
    s_lshl_b32 s50, s44, 8
    s_lshl_b32 s51, s45, 7
    s_add_u32 s50, s50, s51
    s_lshl_b32 s51, s40, 19
    s_add_u32 s50, s50, s51
    v_add_u32 v4, s50, v4
    s_lshl_b32 s51, s40, 13
    v_add_u32 v6, 0x0, v4
    global_load_dwordx4 v[176:179], v6, s[26:27] nt
    v_add_u32 v6, 0x10000, v4
    global_load_dwordx4 v[180:183], v6, s[26:27] nt
    v_add_u32 v6, 0x20000, v4
    global_load_dwordx4 v[184:187], v6, s[26:27] nt
    v_add_u32 v6, 0x30000, v4
    global_load_dwordx4 v[188:191], v6, s[26:27] nt
    v_add_u32 v6, 0x40000, v4
    global_load_dwordx4 v[192:195], v6, s[26:27] nt
    v_add_u32 v6, 0x50000, v4
    global_load_dwordx4 v[196:199], v6, s[26:27] nt
    v_add_u32 v6, 0x60000, v4
    global_load_dwordx4 v[200:203], v6, s[26:27] nt
    v_add_u32 v6, 0x70000, v4
    global_load_dwordx4 v[204:207], v6, s[26:27] nt
    s_lshl_b32 s50, s44, 7
    s_lshl_b32 s51, s45, 6
    s_add_u32 s50, s50, s51
    s_mul_i32 s50, s50, 1152
    s_mul_i32 s51, s40, 576
    s_mov_b32 s53, 58255
    v_add_u32 v3, s51, v2
    v_add_u32 v3, 0, v3
    v_mul_lo_u32 v4, v3, s53
    v_lshrrev_b32 v4, 22, v4
    v_mul_u32_u24 v5, 72, v4
    v_sub_u32 v5, v3, v5
    v_lshrrev_b32 v6, 1, v4
    v_and_b32 v6, 3, v6
    v_lshlrev_b32 v6, 1, v6
    v_xor_b32 v5, v5, v6
    v_mul_u32_u24 v4, 1152, v4
    v_lshl_add_u32 v4, v5, 4, v4
    v_add_u32 v4, s50, v4
    global_load_dwordx4 v[208:211], v4, s[28:29] nt
    v_add_u32 v3, s51, v2
    v_add_u32 v3, 64, v3
    v_mul_lo_u32 v4, v3, s53
    v_lshrrev_b32 v4, 22, v4
    v_mul_u32_u24 v5, 72, v4
    v_sub_u32 v5, v3, v5
    v_lshrrev_b32 v6, 1, v4
    v_and_b32 v6, 3, v6
    v_lshlrev_b32 v6, 1, v6
    v_xor_b32 v5, v5, v6
    v_mul_u32_u24 v4, 1152, v4
    v_lshl_add_u32 v4, v5, 4, v4
    v_add_u32 v4, s50, v4
    global_load_dwordx4 v[212:215], v4, s[28:29] nt
    v_add_u32 v3, s51, v2
    v_add_u32 v3, 128, v3
    v_mul_lo_u32 v4, v3, s53
    v_lshrrev_b32 v4, 22, v4
    v_mul_u32_u24 v5, 72, v4
    v_sub_u32 v5, v3, v5
    v_lshrrev_b32 v6, 1, v4
    v_and_b32 v6, 3, v6
    v_lshlrev_b32 v6, 1, v6
    v_xor_b32 v5, v5, v6
    v_mul_u32_u24 v4, 1152, v4
    v_lshl_add_u32 v4, v5, 4, v4
    v_add_u32 v4, s50, v4
    global_load_dwordx4 v[216:219], v4, s[28:29] nt
    v_add_u32 v3, s51, v2
    v_add_u32 v3, 192, v3
    v_mul_lo_u32 v4, v3, s53
    v_lshrrev_b32 v4, 22, v4
    v_mul_u32_u24 v5, 72, v4
    v_sub_u32 v5, v3, v5
    v_lshrrev_b32 v6, 1, v4
    v_and_b32 v6, 3, v6
    v_lshlrev_b32 v6, 1, v6
    v_xor_b32 v5, v5, v6
    v_mul_u32_u24 v4, 1152, v4
    v_lshl_add_u32 v4, v5, 4, v4
    v_add_u32 v4, s50, v4
    global_load_dwordx4 v[220:223], v4, s[28:29] nt
    v_add_u32 v3, s51, v2
    v_add_u32 v3, 256, v3
    v_mul_lo_u32 v4, v3, s53
    v_lshrrev_b32 v4, 22, v4
    v_mul_u32_u24 v5, 72, v4
    v_sub_u32 v5, v3, v5
    v_lshrrev_b32 v6, 1, v4
    v_and_b32 v6, 3, v6
    v_lshlrev_b32 v6, 1, v6
    v_xor_b32 v5, v5, v6
    v_mul_u32_u24 v4, 1152, v4
    v_lshl_add_u32 v4, v5, 4, v4
    v_add_u32 v4, s50, v4
    global_load_dwordx4 v[224:227], v4, s[28:29] nt
    v_add_u32 v3, s51, v2
    v_add_u32 v3, 320, v3
    v_mul_lo_u32 v4, v3, s53
    v_lshrrev_b32 v4, 22, v4
    v_mul_u32_u24 v5, 72, v4
    v_sub_u32 v5, v3, v5
    v_lshrrev_b32 v6, 1, v4
    v_and_b32 v6, 3, v6
    v_lshlrev_b32 v6, 1, v6
    v_xor_b32 v5, v5, v6
    v_mul_u32_u24 v4, 1152, v4
    v_lshl_add_u32 v4, v5, 4, v4
    v_add_u32 v4, s50, v4
    global_load_dwordx4 v[228:231], v4, s[28:29] nt
    v_add_u32 v3, s51, v2
    v_add_u32 v3, 384, v3
    v_mul_lo_u32 v4, v3, s53
    v_lshrrev_b32 v4, 22, v4
    v_mul_u32_u24 v5, 72, v4
    v_sub_u32 v5, v3, v5
    v_lshrrev_b32 v6, 1, v4
    v_and_b32 v6, 3, v6
    v_lshlrev_b32 v6, 1, v6
    v_xor_b32 v5, v5, v6
    v_mul_u32_u24 v4, 1152, v4
    v_lshl_add_u32 v4, v5, 4, v4
    v_add_u32 v4, s50, v4
    global_load_dwordx4 v[232:235], v4, s[28:29] nt
    v_add_u32 v3, s51, v2
    v_add_u32 v3, 448, v3
    v_mul_lo_u32 v4, v3, s53
    v_lshrrev_b32 v4, 22, v4
    v_mul_u32_u24 v5, 72, v4
    v_sub_u32 v5, v3, v5
    v_lshrrev_b32 v6, 1, v4
    v_and_b32 v6, 3, v6
    v_lshlrev_b32 v6, 1, v6
    v_xor_b32 v5, v5, v6
    v_mul_u32_u24 v4, 1152, v4
    v_lshl_add_u32 v4, v5, 4, v4
    v_add_u32 v4, s50, v4
    global_load_dwordx4 v[236:239], v4, s[28:29] nt
    v_add_u32 v3, s51, v2
    v_add_u32 v3, 512, v3
    v_mul_lo_u32 v4, v3, s53
    v_lshrrev_b32 v4, 22, v4
    v_mul_u32_u24 v5, 72, v4
    v_sub_u32 v5, v3, v5
    v_lshrrev_b32 v6, 1, v4
    v_and_b32 v6, 3, v6
    v_lshlrev_b32 v6, 1, v6
    v_xor_b32 v5, v5, v6
    v_mul_u32_u24 v4, 1152, v4
    v_lshl_add_u32 v4, v5, 4, v4
    v_add_u32 v4, s50, v4
    global_load_dwordx4 v[240:243], v4, s[28:29] nt
B1G_31:
    s_barrier
    s_lshl_b32 s50, s46, 15
    s_lshl_b32 s51, s40, 12
    s_add_u32 s50, s50, s51
    v_lshl_add_u32 v5, v2, 4, s50
    global_load_dwordx4 v[64:67], v5, s[36:37] offset:0 sc1
    global_load_dwordx4 v[68:71], v5, s[36:37] offset:1024 sc1
    global_load_dwordx4 v[72:75], v5, s[36:37] offset:2048 sc1
    global_load_dwordx4 v[76:79], v5, s[36:37] offset:3072 sc1
    s_and_b32 s52, s40, 1
    s_lshl_b32 s52, s52, 3
    s_add_u32 s53, s52, 0
    v_xor_b32 v80, s53, v2
    v_lshlrev_b32 v80, 4, v80
    v_add_u32 v80, s51, v80
    s_add_u32 s53, s52, 2
    v_xor_b32 v81, s53, v2
    v_lshlrev_b32 v81, 4, v81
    v_add_u32 v81, s51, v81
    s_add_u32 s53, s52, 4
    v_xor_b32 v82, s53, v2
    v_lshlrev_b32 v82, 4, v82
    v_add_u32 v82, s51, v82
    s_add_u32 s53, s52, 6
    v_xor_b32 v83, s53, v2
    v_lshlrev_b32 v83, 4, v83
    v_add_u32 v83, s51, v83
    s_waitcnt vmcnt(0)
    v_add_u32 v80, 131072, v80
    v_add_u32 v81, 132096, v81
    v_add_u32 v82, 133120, v82
    v_add_u32 v83, 134144, v83
    ds_write_b128 v80, v[64:67]
    ds_write_b128 v81, v[68:71]
    ds_write_b128 v82, v[72:75]
    ds_write_b128 v83, v[76:79]
    s_cmp_lg_u32 s40, 0
    s_cbranch_scc1 B1H_34
    v_lshrrev_b32 v3, 3, v2
    v_and_b32 v4, 7, v2
    v_lshrrev_b32 v5, 1, v3
    v_and_b32 v5, 3, v5
    v_lshlrev_b32 v5, 1, v5
    v_xor_b32 v4, v4, v5
    v_lshlrev_b32 v4, 4, v4
    v_lshl_add_u32 v4, v3, 13, v4
    s_lshl_b32 s50, s44, 8
    s_lshl_b32 s51, s45, 7
    s_add_u32 s50, s50, s51
    s_lshl_b32 s51, s40, 19
    s_add_u32 s50, s50, s51
    v_add_u32 v4, s50, v4
    s_lshl_b32 s51, s40, 13
    v_add_u32 v6, 0x0, v4
    global_load_dwordx4 v[176:179], v6, s[26:27] nt
    v_add_u32 v6, 0x10000, v4
    global_load_dwordx4 v[180:183], v6, s[26:27] nt
    v_add_u32 v6, 0x20000, v4
    global_load_dwordx4 v[184:187], v6, s[26:27] nt
    v_add_u32 v6, 0x30000, v4
    global_load_dwordx4 v[188:191], v6, s[26:27] nt
    v_add_u32 v6, 0x40000, v4
    global_load_dwordx4 v[192:195], v6, s[26:27] nt
    v_add_u32 v6, 0x50000, v4
    global_load_dwordx4 v[196:199], v6, s[26:27] nt
    v_add_u32 v6, 0x60000, v4
    global_load_dwordx4 v[200:203], v6, s[26:27] nt
    v_add_u32 v6, 0x70000, v4
    global_load_dwordx4 v[204:207], v6, s[26:27] nt
    s_lshl_b32 s50, s44, 7
    s_lshl_b32 s51, s45, 6
    s_add_u32 s50, s50, s51
    s_mul_i32 s50, s50, 1152
    s_mul_i32 s51, s40, 576
    s_mov_b32 s53, 58255
    v_add_u32 v3, s51, v2
    v_add_u32 v3, 0, v3
    v_mul_lo_u32 v4, v3, s53
    v_lshrrev_b32 v4, 22, v4
    v_mul_u32_u24 v5, 72, v4
    v_sub_u32 v5, v3, v5
    v_lshrrev_b32 v6, 1, v4
    v_and_b32 v6, 3, v6
    v_lshlrev_b32 v6, 1, v6
    v_xor_b32 v5, v5, v6
    v_mul_u32_u24 v4, 1152, v4
    v_lshl_add_u32 v4, v5, 4, v4
    v_add_u32 v4, s50, v4
    global_load_dwordx4 v[208:211], v4, s[28:29] nt
    v_add_u32 v3, s51, v2
    v_add_u32 v3, 64, v3
    v_mul_lo_u32 v4, v3, s53
    v_lshrrev_b32 v4, 22, v4
    v_mul_u32_u24 v5, 72, v4
    v_sub_u32 v5, v3, v5
    v_lshrrev_b32 v6, 1, v4
    v_and_b32 v6, 3, v6
    v_lshlrev_b32 v6, 1, v6
    v_xor_b32 v5, v5, v6
    v_mul_u32_u24 v4, 1152, v4
    v_lshl_add_u32 v4, v5, 4, v4
    v_add_u32 v4, s50, v4
    global_load_dwordx4 v[212:215], v4, s[28:29] nt
    v_add_u32 v3, s51, v2
    v_add_u32 v3, 128, v3
    v_mul_lo_u32 v4, v3, s53
    v_lshrrev_b32 v4, 22, v4
    v_mul_u32_u24 v5, 72, v4
    v_sub_u32 v5, v3, v5
    v_lshrrev_b32 v6, 1, v4
    v_and_b32 v6, 3, v6
    v_lshlrev_b32 v6, 1, v6
    v_xor_b32 v5, v5, v6
    v_mul_u32_u24 v4, 1152, v4
    v_lshl_add_u32 v4, v5, 4, v4
    v_add_u32 v4, s50, v4
    global_load_dwordx4 v[216:219], v4, s[28:29] nt
    v_add_u32 v3, s51, v2
    v_add_u32 v3, 192, v3
    v_mul_lo_u32 v4, v3, s53
    v_lshrrev_b32 v4, 22, v4
    v_mul_u32_u24 v5, 72, v4
    v_sub_u32 v5, v3, v5
    v_lshrrev_b32 v6, 1, v4
    v_and_b32 v6, 3, v6
    v_lshlrev_b32 v6, 1, v6
    v_xor_b32 v5, v5, v6
    v_mul_u32_u24 v4, 1152, v4
    v_lshl_add_u32 v4, v5, 4, v4
    v_add_u32 v4, s50, v4
    global_load_dwordx4 v[220:223], v4, s[28:29] nt
    v_add_u32 v3, s51, v2
    v_add_u32 v3, 256, v3
    v_mul_lo_u32 v4, v3, s53
    v_lshrrev_b32 v4, 22, v4
    v_mul_u32_u24 v5, 72, v4
    v_sub_u32 v5, v3, v5
    v_lshrrev_b32 v6, 1, v4
    v_and_b32 v6, 3, v6
    v_lshlrev_b32 v6, 1, v6
    v_xor_b32 v5, v5, v6
    v_mul_u32_u24 v4, 1152, v4
    v_lshl_add_u32 v4, v5, 4, v4
    v_add_u32 v4, s50, v4
    global_load_dwordx4 v[224:227], v4, s[28:29] nt
    v_add_u32 v3, s51, v2
    v_add_u32 v3, 320, v3
    v_mul_lo_u32 v4, v3, s53
    v_lshrrev_b32 v4, 22, v4
    v_mul_u32_u24 v5, 72, v4
    v_sub_u32 v5, v3, v5
    v_lshrrev_b32 v6, 1, v4
    v_and_b32 v6, 3, v6
    v_lshlrev_b32 v6, 1, v6
    v_xor_b32 v5, v5, v6
    v_mul_u32_u24 v4, 1152, v4
    v_lshl_add_u32 v4, v5, 4, v4
    v_add_u32 v4, s50, v4
    global_load_dwordx4 v[228:231], v4, s[28:29] nt
    v_add_u32 v3, s51, v2
    v_add_u32 v3, 384, v3
    v_mul_lo_u32 v4, v3, s53
    v_lshrrev_b32 v4, 22, v4
    v_mul_u32_u24 v5, 72, v4
    v_sub_u32 v5, v3, v5
    v_lshrrev_b32 v6, 1, v4
    v_and_b32 v6, 3, v6
    v_lshlrev_b32 v6, 1, v6
    v_xor_b32 v5, v5, v6
    v_mul_u32_u24 v4, 1152, v4
    v_lshl_add_u32 v4, v5, 4, v4
    v_add_u32 v4, s50, v4
    global_load_dwordx4 v[232:235], v4, s[28:29] nt
    v_add_u32 v3, s51, v2
    v_add_u32 v3, 448, v3
    v_mul_lo_u32 v4, v3, s53
    v_lshrrev_b32 v4, 22, v4
    v_mul_u32_u24 v5, 72, v4
    v_sub_u32 v5, v3, v5
    v_lshrrev_b32 v6, 1, v4
    v_and_b32 v6, 3, v6
    v_lshlrev_b32 v6, 1, v6
    v_xor_b32 v5, v5, v6
    v_mul_u32_u24 v4, 1152, v4
    v_lshl_add_u32 v4, v5, 4, v4
    v_add_u32 v4, s50, v4
    global_load_dwordx4 v[236:239], v4, s[28:29] nt
    v_add_u32 v3, s51, v2
    v_add_u32 v3, 512, v3
    v_mul_lo_u32 v4, v3, s53
    v_lshrrev_b32 v4, 22, v4
    v_mul_u32_u24 v5, 72, v4
    v_sub_u32 v5, v3, v5
    v_lshrrev_b32 v6, 1, v4
    v_and_b32 v6, 3, v6
    v_lshlrev_b32 v6, 1, v6
    v_xor_b32 v5, v5, v6
    v_mul_u32_u24 v4, 1152, v4
    v_lshl_add_u32 v4, v5, 4, v4
    v_add_u32 v4, s50, v4
    global_load_dwordx4 v[240:243], v4, s[28:29] nt
B1H_34:
    s_waitcnt lgkmcnt(0)
    s_barrier
    v_and_b32 v5, 7, v9
    v_lshlrev_b32 v5, 1, v5
    v_xor_b32 v5, v5, v10
    v_lshlrev_b32 v5, 4, v5
    s_lshl_b32 s50, s40, 14
    v_lshlrev_b32 v6, 10, v9
    v_add_u32 v7, s50, v6
    v_add_u32 v8, 131072, v6
    v_xor_b32 v3, 0, v5
    v_add_u32 v4, v3, v7
    v_add_u32 v3, v3, v8
    ds_read_b128 v[64:67], v4
    ds_read_b128 v[68:71], v3
    ds_read_b128 v[72:75], v3 offset:16384
    v_xor_b32 v3, 64, v5
    v_add_u32 v4, v3, v7
    v_add_u32 v3, v3, v8
    ds_read_b128 v[76:79], v4
    ds_read_b128 v[80:83], v3
    ds_read_b128 v[84:87], v3 offset:16384
    v_xor_b32 v3, 128, v5
    v_add_u32 v4, v3, v7
    v_add_u32 v3, v3, v8
    ds_read_b128 v[88:91], v4
    ds_read_b128 v[92:95], v3
    ds_read_b128 v[96:99], v3 offset:16384
    v_xor_b32 v3, 192, v5
    v_add_u32 v4, v3, v7
    v_add_u32 v3, v3, v8
    ds_read_b128 v[100:103], v4
    ds_read_b128 v[104:107], v3
    ds_read_b128 v[108:111], v3 offset:16384
    v_xor_b32 v3, 256, v5
    v_add_u32 v4, v3, v7
    v_add_u32 v3, v3, v8
    ds_read_b128 v[112:115], v4
    ds_read_b128 v[116:119], v3
    ds_read_b128 v[120:123], v3 offset:16384
    v_xor_b32 v3, 320, v5
    v_add_u32 v4, v3, v7
    v_add_u32 v3, v3, v8
    ds_read_b128 v[124:127], v4
    ds_read_b128 v[128:131], v3
    ds_read_b128 v[132:135], v3 offset:16384
    v_xor_b32 v3, 384, v5
    v_add_u32 v4, v3, v7
    v_add_u32 v3, v3, v8
    ds_read_b128 v[136:139], v4
    ds_read_b128 v[140:143], v3
    ds_read_b128 v[144:147], v3 offset:16384
    v_xor_b32 v3, 448, v5
    v_add_u32 v4, v3, v7
    v_add_u32 v3, v3, v8
    ds_read_b128 v[148:151], v4
    ds_read_b128 v[152:155], v3
    ds_read_b128 v[156:159], v3 offset:16384
    s_waitcnt lgkmcnt(12)
    v_mfma_f32_16x16x32_bf16 v[12:15], v[64:67], v[68:71], 0
    v_mfma_f32_16x16x32_bf16 v[16:19], v[64:67], v[72:75], 0
    v_mfma_f32_16x16x32_bf16 v[12:15], v[76:79], v[80:83], v[12:15]
    v_mfma_f32_16x16x32_bf16 v[16:19], v[76:79], v[84:87], v[16:19]
    v_mfma_f32_16x16x32_bf16 v[12:15], v[88:91], v[92:95], v[12:15]
    v_mfma_f32_16x16x32_bf16 v[16:19], v[88:91], v[96:99], v[16:19]
    v_mfma_f32_16x16x32_bf16 v[12:15], v[100:103], v[104:107], v[12:15]
    v_mfma_f32_16x16x32_bf16 v[16:19], v[100:103], v[108:111], v[16:19]
    v_xor_b32 v3, 512, v5
    v_add_u32 v4, v3, v7
    v_add_u32 v3, v3, v8
    ds_read_b128 v[64:67], v4
    ds_read_b128 v[68:71], v3
    ds_read_b128 v[72:75], v3 offset:16384
    v_xor_b32 v3, 576, v5
    v_add_u32 v4, v3, v7
    v_add_u32 v3, v3, v8
    ds_read_b128 v[76:79], v4
    ds_read_b128 v[80:83], v3
    ds_read_b128 v[84:87], v3 offset:16384
    v_xor_b32 v3, 640, v5
    v_add_u32 v4, v3, v7
    v_add_u32 v3, v3, v8
    ds_read_b128 v[88:91], v4
    ds_read_b128 v[92:95], v3
    ds_read_b128 v[96:99], v3 offset:16384
    v_xor_b32 v3, 704, v5
    v_add_u32 v4, v3, v7
    v_add_u32 v3, v3, v8
    ds_read_b128 v[100:103], v4
    ds_read_b128 v[104:107], v3
    ds_read_b128 v[108:111], v3 offset:16384
    s_waitcnt lgkmcnt(12)
    v_mfma_f32_16x16x32_bf16 v[12:15], v[112:115], v[116:119], v[12:15]
    v_mfma_f32_16x16x32_bf16 v[16:19], v[112:115], v[120:123], v[16:19]
    v_mfma_f32_16x16x32_bf16 v[12:15], v[124:127], v[128:131], v[12:15]
    v_mfma_f32_16x16x32_bf16 v[16:19], v[124:127], v[132:135], v[16:19]
    v_mfma_f32_16x16x32_bf16 v[12:15], v[136:139], v[140:143], v[12:15]
    v_mfma_f32_16x16x32_bf16 v[16:19], v[136:139], v[144:147], v[16:19]
    v_mfma_f32_16x16x32_bf16 v[12:15], v[148:151], v[152:155], v[12:15]
    v_mfma_f32_16x16x32_bf16 v[16:19], v[148:151], v[156:159], v[16:19]
    v_xor_b32 v3, 768, v5
    v_add_u32 v4, v3, v7
    v_add_u32 v3, v3, v8
    ds_read_b128 v[112:115], v4
    ds_read_b128 v[116:119], v3
    ds_read_b128 v[120:123], v3 offset:16384
    v_xor_b32 v3, 832, v5
    v_add_u32 v4, v3, v7
    v_add_u32 v3, v3, v8
    ds_read_b128 v[124:127], v4
    ds_read_b128 v[128:131], v3
    ds_read_b128 v[132:135], v3 offset:16384
    v_xor_b32 v3, 896, v5
    v_add_u32 v4, v3, v7
    v_add_u32 v3, v3, v8
    ds_read_b128 v[136:139], v4
    ds_read_b128 v[140:143], v3
    ds_read_b128 v[144:147], v3 offset:16384
    v_xor_b32 v3, 960, v5
    v_add_u32 v4, v3, v7
    v_add_u32 v3, v3, v8
    ds_read_b128 v[148:151], v4
    ds_read_b128 v[152:155], v3
    ds_read_b128 v[156:159], v3 offset:16384
    s_waitcnt lgkmcnt(12)
    v_mfma_f32_16x16x32_bf16 v[12:15], v[64:67], v[68:71], v[12:15]
    v_mfma_f32_16x16x32_bf16 v[16:19], v[64:67], v[72:75], v[16:19]
    v_mfma_f32_16x16x32_bf16 v[12:15], v[76:79], v[80:83], v[12:15]
    v_mfma_f32_16x16x32_bf16 v[16:19], v[76:79], v[84:87], v[16:19]
    v_mfma_f32_16x16x32_bf16 v[12:15], v[88:91], v[92:95], v[12:15]
    v_mfma_f32_16x16x32_bf16 v[16:19], v[88:91], v[96:99], v[16:19]
    v_mfma_f32_16x16x32_bf16 v[12:15], v[100:103], v[104:107], v[12:15]
    v_mfma_f32_16x16x32_bf16 v[16:19], v[100:103], v[108:111], v[16:19]
    s_waitcnt lgkmcnt(0)
    v_mfma_f32_16x16x32_bf16 v[12:15], v[112:115], v[116:119], v[12:15]
    v_mfma_f32_16x16x32_bf16 v[16:19], v[112:115], v[120:123], v[16:19]
    v_mfma_f32_16x16x32_bf16 v[12:15], v[124:127], v[128:131], v[12:15]
    v_mfma_f32_16x16x32_bf16 v[16:19], v[124:127], v[132:135], v[16:19]
    v_mfma_f32_16x16x32_bf16 v[12:15], v[136:139], v[140:143], v[12:15]
    v_mfma_f32_16x16x32_bf16 v[16:19], v[136:139], v[144:147], v[16:19]
    v_mfma_f32_16x16x32_bf16 v[12:15], v[148:151], v[152:155], v[12:15]
    v_mfma_f32_16x16x32_bf16 v[16:19], v[148:151], v[156:159], v[16:19]
    s_nop 7
    s_nop 1
    v_max3_f32 v20, v12, v13, v14
    v_max_f32 v20, v20, v15
    v_mov_b32 v3, v20
    s_nop 1
    v_permlane16_swap_b32 v20, v3
    s_nop 1
    v_max_f32 v20, v20, v3
    v_mov_b32 v3, v20
    s_nop 1
    v_permlane32_swap_b32 v20, v3
    s_nop 1
    v_max_f32 v20, v20, v3
    v_max3_f32 v21, v16, v17, v18
    v_max_f32 v21, v21, v19
    v_mov_b32 v3, v21
    s_nop 1
    v_permlane16_swap_b32 v21, v3
    s_nop 1
    v_max_f32 v21, v21, v3
    v_mov_b32 v3, v21
    s_nop 1
    v_permlane32_swap_b32 v21, v3
    s_nop 1
    v_max_f32 v21, v21, v3
    s_barrier
    s_lshl_b32 s50, s40, 7
    v_lshl_add_u32 v3, v9, 2, s50
    v_add_u32 v3, 131072, v3
    s_mov_b64 exec, 0xffff
    ds_write_b32 v3, v20
    ds_write_b32 v3, v21 offset:64
    s_mov_b64 exec, -1
    s_waitcnt lgkmcnt(0)
    s_barrier
    v_lshlrev_b32 v4, 2, v9
    v_add_u32 v4, 131072, v4
    ds_read_b32 v64, v4 offset:0
    ds_read_b32 v65, v4 offset:128
    ds_read_b32 v66, v4 offset:256
    ds_read_b32 v67, v4 offset:384
    ds_read_b32 v68, v4 offset:512
    ds_read_b32 v69, v4 offset:640
    ds_read_b32 v70, v4 offset:768
    ds_read_b32 v71, v4 offset:896
    ds_read_b32 v72, v4 offset:64
    ds_read_b32 v73, v4 offset:192
    ds_read_b32 v74, v4 offset:320
    ds_read_b32 v75, v4 offset:448
    ds_read_b32 v76, v4 offset:576
    ds_read_b32 v77, v4 offset:704
    ds_read_b32 v78, v4 offset:832
    ds_read_b32 v79, v4 offset:960
    s_waitcnt lgkmcnt(0)
    v_max3_f32 v22, v64, v65, v66
    v_max3_f32 v22, v22, v67, v68
    v_max3_f32 v22, v22, v69, v70
    v_max_f32 v22, v22, v71
    v_mul_f32 v3, s43, v22
    v_fma_f32 v12, v12, s43, -v3
    v_fma_f32 v13, v13, s43, -v3
    v_fma_f32 v14, v14, s43, -v3
    v_fma_f32 v15, v15, s43, -v3
    v_exp_f32 v12, v12
    v_exp_f32 v13, v13
    v_exp_f32 v14, v14
    v_exp_f32 v15, v15
    v_max3_f32 v23, v72, v73, v74
    v_max3_f32 v23, v23, v75, v76
    v_max3_f32 v23, v23, v77, v78
    v_max_f32 v23, v23, v79
    v_mul_f32 v3, s43, v23
    v_fma_f32 v16, v16, s43, -v3
    v_fma_f32 v17, v17, s43, -v3
    v_fma_f32 v18, v18, s43, -v3
    v_fma_f32 v19, v19, s43, -v3
    v_exp_f32 v16, v16
    v_exp_f32 v17, v17
    v_exp_f32 v18, v18
    v_exp_f32 v19, v19
    v_add_f32 v24, v12, v13
    v_add_f32 v3, v14, v15
    v_add_f32 v24, v24, v3
    v_mov_b32 v3, v24
    s_nop 1
    v_permlane16_swap_b32 v24, v3
    s_nop 1
    v_add_f32 v24, v24, v3
    v_mov_b32 v3, v24
    s_nop 1
    v_permlane32_swap_b32 v24, v3
    s_nop 1
    v_add_f32 v24, v24, v3
    v_add_f32 v25, v16, v17
    v_add_f32 v3, v18, v19
    v_add_f32 v25, v25, v3
    v_mov_b32 v3, v25
    s_nop 1
    v_permlane16_swap_b32 v25, v3
    s_nop 1
    v_add_f32 v25, v25, v3
    v_mov_b32 v3, v25
    s_nop 1
    v_permlane32_swap_b32 v25, v3
    s_nop 1
    v_add_f32 v25, v25, v3
    s_lshl_b32 s50, s40, 5
    v_mul_u32_u24 v4, 288, v9
    v_lshl_add_u32 v4, v10, 3, v4
    v_add_u32 v4, s50, v4
    v_add_u32 v4, 133120, v4
    v_cvt_pk_bf16_f32 v26, v12, v13
    v_cvt_pk_bf16_f32 v27, v14, v15
    ds_write_b64 v4, v[26:27] offset:0
    v_cvt_pk_bf16_f32 v28, v16, v17
    v_cvt_pk_bf16_f32 v29, v18, v19
    ds_write_b64 v4, v[28:29] offset:4608
    s_lshl_b32 s50, s40, 7
    v_lshl_add_u32 v3, v9, 2, s50
    v_add_u32 v3, 132096, v3
    s_mov_b64 exec, 0xffff
    ds_write_b32 v3, v24
    ds_write_b32 v3, v25 offset:64
    s_mov_b64 exec, -1
    s_waitcnt lgkmcnt(0)
    s_barrier
    s_cmp_lg_u32 s40, 0
    s_cbranch_scc1 B2S_35
    v_lshlrev_b32 v4, 2, v9
    v_add_u32 v4, 132096, v4
    ds_read_b32 v64, v4 offset:0
    ds_read_b32 v65, v4 offset:128
    ds_read_b32 v66, v4 offset:256
    ds_read_b32 v67, v4 offset:384
    ds_read_b32 v68, v4 offset:512
    ds_read_b32 v69, v4 offset:640
    ds_read_b32 v70, v4 offset:768
    ds_read_b32 v71, v4 offset:896
    ds_read_b32 v72, v4 offset:64
    ds_read_b32 v73, v4 offset:192
    ds_read_b32 v74, v4 offset:320
    ds_read_b32 v75, v4 offset:448
    ds_read_b32 v76, v4 offset:576
    ds_read_b32 v77, v4 offset:704
    ds_read_b32 v78, v4 offset:832
    ds_read_b32 v79, v4 offset:960
    s_waitcnt lgkmcnt(0)
    v_add_f32 v64, v64, v68
    v_add_f32 v65, v65, v69
    v_add_f32 v66, v66, v70
    v_add_f32 v67, v67, v71
    v_add_f32 v64, v64, v66
    v_add_f32 v65, v65, v67
    v_add_f32 v64, v64, v65
    v_add_f32 v72, v72, v76
    v_add_f32 v73, v73, v77
    v_add_f32 v74, v74, v78
    v_add_f32 v75, v75, v79
    v_add_f32 v72, v72, v74
    v_add_f32 v73, v73, v75
    v_add_f32 v72, v72, v73
    s_lshl_b32 s50, s2, 8
    s_add_u32 s50, s50, 0x10000
    v_lshl_add_u32 v4, v9, 3, s50
    s_mov_b64 exec, 0xffff
    v_mov_b32 v6, v22
    v_mov_b32 v7, v64
    global_store_dwordx2 v4, v[6:7], s[36:37] offset:0 sc1
    s_nop 1
    v_mov_b32 v6, v23
    v_mov_b32 v7, v72
    global_store_dwordx2 v4, v[6:7], s[36:37] offset:128 sc1
    s_nop 1
    s_mov_b64 exec, -1
B2S_35:
    v_lshrrev_b32 v3, 2, v9
    v_lshl_add_u32 v3, v10, 2, v3
    v_and_b32 v4, 7, v3
    v_lshlrev_b32 v4, 1, v4
    v_lshlrev_b32 v3, 10, v3
    v_and_b32 v5, 3, v9
    v_lshrrev_b32 v6, 1, v5
    v_and_b32 v5, 1, v5
    v_lshl_add_u32 v3, v5, 3, v3
    s_lshl_b32 s50, s40, 3
    v_add_u32 v6, s50, v6
    v_add_u32 v7, 0, v6
    v_xor_b32 v7, v7, v4
    v_lshl_add_u32 v32, v7, 4, v3
    v_add_u32 v36, 0x10000, v32
    v_add_u32 v7, 2, v6
    v_xor_b32 v7, v7, v4
    v_lshl_add_u32 v33, v7, 4, v3
    v_add_u32 v37, 0x10000, v33
    v_add_u32 v7, 4, v6
    v_xor_b32 v7, v7, v4
    v_lshl_add_u32 v34, v7, 4, v3
    v_add_u32 v38, 0x10000, v34
    v_add_u32 v7, 6, v6
    v_xor_b32 v7, v7, v4
    v_lshl_add_u32 v35, v7, 4, v3
    v_add_u32 v39, 0x10000, v35
    v_mul_u32_u24 v7, 288, v9
    v_lshl_add_u32 v7, v10, 3, v7
    v_add_u32 v7, 133120, v7
    v_add_u32 v8, 4608, v7
    ds_read2_b64 v[40:43], v7 offset0:0 offset1:4
    ds_read2_b64 v[44:47], v7 offset0:8 offset1:12
    ds_read2_b64 v[48:51], v7 offset0:16 offset1:20
    ds_read2_b64 v[52:55], v7 offset0:24 offset1:28
    ds_read2_b64 v[56:59], v8 offset0:0 offset1:4
    ds_read2_b64 v[60:63], v8 offset0:8 offset1:12
    ds_read2_b64 v[64:67], v8 offset0:16 offset1:20
    ds_read2_b64 v[68:71], v8 offset0:24 offset1:28
    ds_read_b64_tr_b16 v[80:81], v32 offset:0
    ds_read_b64_tr_b16 v[82:83], v32 offset:16384
    ds_read_b64_tr_b16 v[84:85], v32 offset:32768
    ds_read_b64_tr_b16 v[86:87], v32 offset:49152
    ds_read_b64_tr_b16 v[88:89], v36 offset:0
    ds_read_b64_tr_b16 v[90:91], v36 offset:16384
    ds_read_b64_tr_b16 v[92:93], v36 offset:32768
    ds_read_b64_tr_b16 v[94:95], v36 offset:49152
    ds_read_b64_tr_b16 v[96:97], v33 offset:0
    ds_read_b64_tr_b16 v[98:99], v33 offset:16384
    ds_read_b64_tr_b16 v[100:101], v33 offset:32768
    ds_read_b64_tr_b16 v[102:103], v33 offset:49152
    ds_read_b64_tr_b16 v[104:105], v37 offset:0
    ds_read_b64_tr_b16 v[106:107], v37 offset:16384
    ds_read_b64_tr_b16 v[108:109], v37 offset:32768
    ds_read_b64_tr_b16 v[110:111], v37 offset:49152
    ds_read_b64_tr_b16 v[112:113], v34 offset:0
    ds_read_b64_tr_b16 v[114:115], v34 offset:16384
    ds_read_b64_tr_b16 v[116:117], v34 offset:32768
    ds_read_b64_tr_b16 v[118:119], v34 offset:49152
    ds_read_b64_tr_b16 v[120:121], v38 offset:0
    ds_read_b64_tr_b16 v[122:123], v38 offset:16384
    ds_read_b64_tr_b16 v[124:125], v38 offset:32768
    ds_read_b64_tr_b16 v[126:127], v38 offset:49152
    ds_read_b64_tr_b16 v[128:129], v35 offset:0
    ds_read_b64_tr_b16 v[130:131], v35 offset:16384
    ds_read_b64_tr_b16 v[132:133], v35 offset:32768
    ds_read_b64_tr_b16 v[134:135], v35 offset:49152
    ds_read_b64_tr_b16 v[136:137], v39 offset:0
    ds_read_b64_tr_b16 v[138:139], v39 offset:16384
    ds_read_b64_tr_b16 v[140:141], v39 offset:32768
    ds_read_b64_tr_b16 v[142:143], v39 offset:49152
    s_waitcnt lgkmcnt(0)
    v_mfma_f32_16x16x32_bf16 v[144:147], v[80:83], v[40:43], 0
    v_mfma_f32_16x16x32_bf16 v[148:151], v[96:99], v[40:43], 0
    v_mfma_f32_16x16x32_bf16 v[152:155], v[112:115], v[40:43], 0
    v_mfma_f32_16x16x32_bf16 v[156:159], v[128:131], v[40:43], 0
    v_mfma_f32_16x16x32_bf16 v[160:163], v[80:83], v[56:59], 0
    v_mfma_f32_16x16x32_bf16 v[164:167], v[96:99], v[56:59], 0
    v_mfma_f32_16x16x32_bf16 v[168:171], v[112:115], v[56:59], 0
    v_mfma_f32_16x16x32_bf16 v[172:175], v[128:131], v[56:59], 0
    v_mfma_f32_16x16x32_bf16 v[144:147], v[84:87], v[44:47], v[144:147]
    v_mfma_f32_16x16x32_bf16 v[148:151], v[100:103], v[44:47], v[148:151]
    v_mfma_f32_16x16x32_bf16 v[152:155], v[116:119], v[44:47], v[152:155]
    v_mfma_f32_16x16x32_bf16 v[156:159], v[132:135], v[44:47], v[156:159]
    v_mfma_f32_16x16x32_bf16 v[160:163], v[84:87], v[60:63], v[160:163]
    v_mfma_f32_16x16x32_bf16 v[164:167], v[100:103], v[60:63], v[164:167]
    v_mfma_f32_16x16x32_bf16 v[168:171], v[116:119], v[60:63], v[168:171]
    v_mfma_f32_16x16x32_bf16 v[172:175], v[132:135], v[60:63], v[172:175]
    v_mfma_f32_16x16x32_bf16 v[144:147], v[88:91], v[48:51], v[144:147]
    v_mfma_f32_16x16x32_bf16 v[148:151], v[104:107], v[48:51], v[148:151]
    v_mfma_f32_16x16x32_bf16 v[152:155], v[120:123], v[48:51], v[152:155]
    v_mfma_f32_16x16x32_bf16 v[156:159], v[136:139], v[48:51], v[156:159]
    v_mfma_f32_16x16x32_bf16 v[160:163], v[88:91], v[64:67], v[160:163]
    v_mfma_f32_16x16x32_bf16 v[164:167], v[104:107], v[64:67], v[164:167]
    v_mfma_f32_16x16x32_bf16 v[168:171], v[120:123], v[64:67], v[168:171]
    v_mfma_f32_16x16x32_bf16 v[172:175], v[136:139], v[64:67], v[172:175]
    v_mfma_f32_16x16x32_bf16 v[144:147], v[92:95], v[52:55], v[144:147]
    v_mfma_f32_16x16x32_bf16 v[148:151], v[108:111], v[52:55], v[148:151]
    v_mfma_f32_16x16x32_bf16 v[152:155], v[124:127], v[52:55], v[152:155]
    v_mfma_f32_16x16x32_bf16 v[156:159], v[140:143], v[52:55], v[156:159]
    v_mfma_f32_16x16x32_bf16 v[160:163], v[92:95], v[68:71], v[160:163]
    v_mfma_f32_16x16x32_bf16 v[164:167], v[108:111], v[68:71], v[164:167]
    v_mfma_f32_16x16x32_bf16 v[168:171], v[124:127], v[68:71], v[168:171]
    v_mfma_f32_16x16x32_bf16 v[172:175], v[140:143], v[68:71], v[172:175]
    s_nop 7
    s_nop 1
    s_lshl_b32 s50, s2, 15
    s_lshl_b32 s51, s40, 7
    s_add_u32 s50, s50, s51
    s_add_u32 s50, s50, 0x100000
    v_lshlrev_b32 v3, 10, v9
    v_lshl_add_u32 v3, v10, 5, v3
    v_add_u32 v3, s50, v3
    v_cvt_pk_bf16_f32 v64, v144, v145
    v_cvt_pk_bf16_f32 v65, v146, v147
    v_cvt_pk_bf16_f32 v66, v148, v149
    v_cvt_pk_bf16_f32 v67, v150, v151
    v_cvt_pk_bf16_f32 v68, v152, v153
    v_cvt_pk_bf16_f32 v69, v154, v155
    v_cvt_pk_bf16_f32 v70, v156, v157
    v_cvt_pk_bf16_f32 v71, v158, v159
    v_cvt_pk_bf16_f32 v72, v160, v161
    v_cvt_pk_bf16_f32 v73, v162, v163
    v_cvt_pk_bf16_f32 v74, v164, v165
    v_cvt_pk_bf16_f32 v75, v166, v167
    v_cvt_pk_bf16_f32 v76, v168, v169
    v_cvt_pk_bf16_f32 v77, v170, v171
    v_cvt_pk_bf16_f32 v78, v172, v173
    v_cvt_pk_bf16_f32 v79, v174, v175
    v_add_u32 v4, 16384, v3
    global_store_dwordx4 v3, v[64:67], s[36:37] sc1
    global_store_dwordx4 v3, v[68:71], s[36:37] offset:16 sc1
    global_store_dwordx4 v4, v[72:75], s[36:37] sc1
    global_store_dwordx4 v4, v[76:79], s[36:37] offset:16 sc1
    s_waitcnt vmcnt(0)
    s_barrier
    s_cmp_lg_u32 s40, 0
    s_cbranch_scc1 B2F_36
    s_lshl_b32 s50, s2, 2
    s_add_u32 s50, s50, 0x385000
    v_lshl_add_u32 v5, v2, 8, s50
    v_mov_b32 v6, s92
    s_mov_b64 exec, 0xff
    global_store_dword v5, v6, s[36:37] sc1
    s_mov_b64 exec, -1
B2F_36:
    s_cmp_lg_u32 s40, 0
    s_cbranch_scc1 B3P_37
    s_and_b32 s50, s2, 7
    s_lshl_b32 s50, s50, 8
    s_add_u32 s50, s50, 0x385000
    v_lshl_add_u32 v5, v2, 2, s50
    s_mov_b32 s51, 0
POLL_38:
    global_load_dword v6, v5, s[36:37] sc1
    s_waitcnt vmcnt(0)
    v_cmp_ne_u32 vcc, s92, v6
    s_nop 1
    s_cmp_eq_u64 vcc, 0
    s_cbranch_scc1 POLLX_39
    s_add_u32 s51, s51, 1
    s_cmp_gt_u32 s51, 1048576
    s_cbranch_scc1 POLLX_39
    s_sleep 2
    s_branch POLL_38
POLLX_39:
    s_mov_b64 exec, -1
B3P_37:
    s_lshl_b32 s51, s40, 13
    v_lshl_add_u32 v3, v2, 4, s51
    ds_write_b128 v3, v[176:179] offset:0
    ds_write_b128 v3, v[180:183] offset:1024
    ds_write_b128 v3, v[184:187] offset:2048
    ds_write_b128 v3, v[188:191] offset:3072
    ds_write_b128 v3, v[192:195] offset:4096
    ds_write_b128 v3, v[196:199] offset:5120
    ds_write_b128 v3, v[200:203] offset:6144
    ds_write_b128 v3, v[204:207] offset:7168
    s_mul_i32 s51, s40, 9216
    s_add_u32 s51, s51, 65536
    v_lshl_add_u32 v3, v2, 4, s51
    ds_write_b128 v3, v[208:211] offset:0
    ds_write_b128 v3, v[212:215] offset:1024
    ds_write_b128 v3, v[216:219] offset:2048
    ds_write_b128 v3, v[220:223] offset:3072
    ds_write_b128 v3, v[224:227] offset:4096
    ds_write_b128 v3, v[228:231] offset:5120
    ds_write_b128 v3, v[232:235] offset:6144
    ds_write_b128 v3, v[236:239] offset:7168
    ds_write_b128 v3, v[240:243] offset:8192
    s_barrier
    s_lshr_b32 s50, s40, 2
    s_and_b32 s51, s40, 3
    s_lshl_b32 s51, s51, 3
    s_lshl_b32 s52, s50, 5
    s_add_u32 s52, s52, s51
    s_lshl_b32 s52, s52, 15
    s_lshl_b32 s53, s44, 10
    s_add_u32 s52, s52, s53
    s_add_u32 s52, s52, 0x100000
    v_lshl_add_u32 v3, v2, 4, s52
    v_add_u32 v4, 0x0, v3
    global_load_dwordx4 v[64:67], v4, s[36:37] sc1
    v_add_u32 v4, 0x8000, v3
    global_load_dwordx4 v[68:71], v4, s[36:37] sc1
    v_add_u32 v4, 0x10000, v3
    global_load_dwordx4 v[72:75], v4, s[36:37] sc1
    v_add_u32 v4, 0x18000, v3
    global_load_dwordx4 v[76:79], v4, s[36:37] sc1
    v_add_u32 v4, 0x20000, v3
    global_load_dwordx4 v[80:83], v4, s[36:37] sc1
    v_add_u32 v4, 0x28000, v3
    global_load_dwordx4 v[84:87], v4, s[36:37] sc1
    v_add_u32 v4, 0x30000, v3
    global_load_dwordx4 v[88:91], v4, s[36:37] sc1
    v_add_u32 v4, 0x38000, v3
    global_load_dwordx4 v[92:95], v4, s[36:37] sc1
    s_lshl_b32 s52, s50, 13
    s_lshl_b32 s53, s44, 3
    s_add_u32 s52, s52, s53
    s_add_u32 s52, s52, 0x10000
    v_and_b32 v4, 31, v2
    v_lshl_add_u32 v4, v4, 8, s52
    global_load_dwordx2 v[6:7], v4, s[36:37] sc1
    s_waitcnt vmcnt(0)
    v_mov_b32 v5, v6
    s_nop 1
    v_max_f32_dpp v5, v5, v5 row_ror:8 row_mask:0xf bank_mask:0xf
    s_nop 1
    v_max_f32_dpp v5, v5, v5 row_ror:4 row_mask:0xf bank_mask:0xf
    s_nop 1
    v_max_f32_dpp v5, v5, v5 row_ror:2 row_mask:0xf bank_mask:0xf
    s_nop 1
    v_max_f32_dpp v5, v5, v5 row_ror:1 row_mask:0xf bank_mask:0xf
    v_mov_b32 v3, v5
    s_nop 1
    v_permlane16_swap_b32 v5, v3
    s_nop 1
    v_max_f32 v5, v5, v3
    v_sub_f32 v6, v6, v5
    v_mul_f32 v6, s43, v6
    v_exp_f32 v6, v6
    s_nop 0
    v_mul_f32 v7, v6, v7
    s_nop 1
    v_add_f32_dpp v7, v7, v7 row_ror:8 row_mask:0xf bank_mask:0xf
    s_nop 1
    v_add_f32_dpp v7, v7, v7 row_ror:4 row_mask:0xf bank_mask:0xf
    s_nop 1
    v_add_f32_dpp v7, v7, v7 row_ror:2 row_mask:0xf bank_mask:0xf
    s_nop 1
    v_add_f32_dpp v7, v7, v7 row_ror:1 row_mask:0xf bank_mask:0xf
    v_mov_b32 v3, v7
    s_nop 1
    v_permlane16_swap_b32 v7, v3
    s_nop 1
    v_add_f32 v7, v7, v3
    v_rcp_f32 v7, v7
    s_nop 0
    v_mul_f32 v6, v6, v7
    s_nop 0
    s_add_u32 s53, s51, 0
    v_readlane_b32 s60, v6, s53
    s_add_u32 s53, s51, 1
    v_readlane_b32 s61, v6, s53
    s_add_u32 s53, s51, 2
    v_readlane_b32 s62, v6, s53
    s_add_u32 s53, s51, 3
    v_readlane_b32 s63, v6, s53
    s_add_u32 s53, s51, 4
    v_readlane_b32 s64, v6, s53
    s_add_u32 s53, s51, 5
    v_readlane_b32 s65, v6, s53
    s_add_u32 s53, s51, 6
    v_readlane_b32 s66, v6, s53
    s_add_u32 s53, s51, 7
    v_readlane_b32 s67, v6, s53
    v_mov_b32 v12, 0
    v_mov_b32 v13, 0
    v_mov_b32 v14, 0
    v_mov_b32 v15, 0
    v_mov_b32 v16, 0
    v_mov_b32 v17, 0
    v_mov_b32 v18, 0
    v_mov_b32 v19, 0
    s_nop 1
    v_lshlrev_b32 v3, 16, v64
    v_and_b32 v4, 0xffff0000, v64
    v_fmac_f32 v12, s60, v3
    v_fmac_f32 v13, s60, v4
    v_lshlrev_b32 v3, 16, v65
    v_and_b32 v4, 0xffff0000, v65
    v_fmac_f32 v14, s60, v3
    v_fmac_f32 v15, s60, v4
    v_lshlrev_b32 v3, 16, v66
    v_and_b32 v4, 0xffff0000, v66
    v_fmac_f32 v16, s60, v3
    v_fmac_f32 v17, s60, v4
    v_lshlrev_b32 v3, 16, v67
    v_and_b32 v4, 0xffff0000, v67
    v_fmac_f32 v18, s60, v3
    v_fmac_f32 v19, s60, v4
    v_lshlrev_b32 v3, 16, v68
    v_and_b32 v4, 0xffff0000, v68
    v_fmac_f32 v12, s61, v3
    v_fmac_f32 v13, s61, v4
    v_lshlrev_b32 v3, 16, v69
    v_and_b32 v4, 0xffff0000, v69
    v_fmac_f32 v14, s61, v3
    v_fmac_f32 v15, s61, v4
    v_lshlrev_b32 v3, 16, v70
    v_and_b32 v4, 0xffff0000, v70
    v_fmac_f32 v16, s61, v3
    v_fmac_f32 v17, s61, v4
    v_lshlrev_b32 v3, 16, v71
    v_and_b32 v4, 0xffff0000, v71
    v_fmac_f32 v18, s61, v3
    v_fmac_f32 v19, s61, v4
    v_lshlrev_b32 v3, 16, v72
    v_and_b32 v4, 0xffff0000, v72
    v_fmac_f32 v12, s62, v3
    v_fmac_f32 v13, s62, v4
    v_lshlrev_b32 v3, 16, v73
    v_and_b32 v4, 0xffff0000, v73
    v_fmac_f32 v14, s62, v3
    v_fmac_f32 v15, s62, v4
    v_lshlrev_b32 v3, 16, v74
    v_and_b32 v4, 0xffff0000, v74
    v_fmac_f32 v16, s62, v3
    v_fmac_f32 v17, s62, v4
    v_lshlrev_b32 v3, 16, v75
    v_and_b32 v4, 0xffff0000, v75
    v_fmac_f32 v18, s62, v3
    v_fmac_f32 v19, s62, v4
    v_lshlrev_b32 v3, 16, v76
    v_and_b32 v4, 0xffff0000, v76
    v_fmac_f32 v12, s63, v3
    v_fmac_f32 v13, s63, v4
    v_lshlrev_b32 v3, 16, v77
    v_and_b32 v4, 0xffff0000, v77
    v_fmac_f32 v14, s63, v3
    v_fmac_f32 v15, s63, v4
    v_lshlrev_b32 v3, 16, v78
    v_and_b32 v4, 0xffff0000, v78
    v_fmac_f32 v16, s63, v3
    v_fmac_f32 v17, s63, v4
    v_lshlrev_b32 v3, 16, v79
    v_and_b32 v4, 0xffff0000, v79
    v_fmac_f32 v18, s63, v3
    v_fmac_f32 v19, s63, v4
    v_lshlrev_b32 v3, 16, v80
    v_and_b32 v4, 0xffff0000, v80
    v_fmac_f32 v12, s64, v3
    v_fmac_f32 v13, s64, v4
    v_lshlrev_b32 v3, 16, v81
    v_and_b32 v4, 0xffff0000, v81
    v_fmac_f32 v14, s64, v3
    v_fmac_f32 v15, s64, v4
    v_lshlrev_b32 v3, 16, v82
    v_and_b32 v4, 0xffff0000, v82
    v_fmac_f32 v16, s64, v3
    v_fmac_f32 v17, s64, v4
    v_lshlrev_b32 v3, 16, v83
    v_and_b32 v4, 0xffff0000, v83
    v_fmac_f32 v18, s64, v3
    v_fmac_f32 v19, s64, v4
    v_lshlrev_b32 v3, 16, v84
    v_and_b32 v4, 0xffff0000, v84
    v_fmac_f32 v12, s65, v3
    v_fmac_f32 v13, s65, v4
    v_lshlrev_b32 v3, 16, v85
    v_and_b32 v4, 0xffff0000, v85
    v_fmac_f32 v14, s65, v3
    v_fmac_f32 v15, s65, v4
    v_lshlrev_b32 v3, 16, v86
    v_and_b32 v4, 0xffff0000, v86
    v_fmac_f32 v16, s65, v3
    v_fmac_f32 v17, s65, v4
    v_lshlrev_b32 v3, 16, v87
    v_and_b32 v4, 0xffff0000, v87
    v_fmac_f32 v18, s65, v3
    v_fmac_f32 v19, s65, v4
    v_lshlrev_b32 v3, 16, v88
    v_and_b32 v4, 0xffff0000, v88
    v_fmac_f32 v12, s66, v3
    v_fmac_f32 v13, s66, v4
    v_lshlrev_b32 v3, 16, v89
    v_and_b32 v4, 0xffff0000, v89
    v_fmac_f32 v14, s66, v3
    v_fmac_f32 v15, s66, v4
    v_lshlrev_b32 v3, 16, v90
    v_and_b32 v4, 0xffff0000, v90
    v_fmac_f32 v16, s66, v3
    v_fmac_f32 v17, s66, v4
    v_lshlrev_b32 v3, 16, v91
    v_and_b32 v4, 0xffff0000, v91
    v_fmac_f32 v18, s66, v3
    v_fmac_f32 v19, s66, v4
    v_lshlrev_b32 v3, 16, v92
    v_and_b32 v4, 0xffff0000, v92
    v_fmac_f32 v12, s67, v3
    v_fmac_f32 v13, s67, v4
    v_lshlrev_b32 v3, 16, v93
    v_and_b32 v4, 0xffff0000, v93
    v_fmac_f32 v14, s67, v3
    v_fmac_f32 v15, s67, v4
    v_lshlrev_b32 v3, 16, v94
    v_and_b32 v4, 0xffff0000, v94
    v_fmac_f32 v16, s67, v3
    v_fmac_f32 v17, s67, v4
    v_lshlrev_b32 v3, 16, v95
    v_and_b32 v4, 0xffff0000, v95
    v_fmac_f32 v18, s67, v3
    v_fmac_f32 v19, s67, v4
    v_lshrrev_b32 v3, 3, v2
    v_bfe_u32 v4, v2, 1, 2
    v_and_b32 v5, 1, v2
    v_lshlrev_b32 v3, 8, v3
    v_lshl_add_u32 v3, v5, 7, v3
    v_lshl_add_u32 v3, v4, 4, v3
    s_lshl_b32 s52, s40, 11
    v_add_u32 v3, s52, v3
    v_add_u32 v3, 139264, v3
    ds_write_b128 v3, v[12:15]
    ds_write_b128 v3, v[16:19] offset:64
    s_waitcnt lgkmcnt(0)
    s_barrier
    v_lshrrev_b32 v3, 8, v0
    v_and_b32 v4, 255, v0
    v_lshlrev_b32 v5, 13, v3
    v_lshl_add_u32 v5, v4, 3, v5
    v_add_u32 v5, 139264, v5
    ds_read_b64 v[12:13], v5 offset:0
    ds_read_b64 v[14:15], v5 offset:2048
    ds_read_b64 v[16:17], v5 offset:4096
    ds_read_b64 v[18:19], v5 offset:6144
    s_waitcnt lgkmcnt(0)
    v_add_f32 v12, v12, v14
    v_add_f32 v16, v16, v18
    v_add_f32 v12, v12, v16
    v_add_f32 v13, v13, v15
    v_add_f32 v17, v17, v19
    v_add_f32 v13, v13, v17
    v_cvt_pk_bf16_f32 v6, v12, v13
    v_lshlrev_b32 v5, 2, v0
    v_add_u32 v5, 155648, v5
    ds_write_b32 v5, v6
    s_waitcnt vmcnt(0)
    s_waitcnt lgkmcnt(0)
    s_barrier
    v_mov_b32 v12, 0
    v_mov_b32 v13, 0
    v_mov_b32 v14, 0
    v_mov_b32 v15, 0
    v_mov_b32 v16, 0
    v_mov_b32 v17, 0
    v_mov_b32 v18, 0
    v_mov_b32 v19, 0
    s_lshl_b32 s50, s40, 7
    v_lshlrev_b32 v3, 10, v9
    v_lshl_add_u32 v3, v10, 3, v3
    v_add_u32 v3, s50, v3
    v_add_u32 v3, 155648, v3
    v_cmp_gt_u32 vcc, 2, v9
    s_and_saveexec_b64 s[58:59], vcc
    ds_read2_b64 v[12:15], v3 offset0:0 offset1:4
    ds_read2_b64 v[16:19], v3 offset0:8 offset1:12
    s_mov_b64 exec, s[58:59]
    v_lshrrev_b32 v3, 2, v9
    v_lshl_add_u32 v3, v10, 2, v3
    v_lshrrev_b32 v4, 1, v3
    v_and_b32 v4, 3, v4
    v_lshlrev_b32 v4, 1, v4
    v_lshlrev_b32 v3, 7, v3
    v_and_b32 v5, 1, v9
    v_lshl_add_u32 v3, v5, 3, v3
    s_lshl_b32 s50, s40, 13
    v_add_u32 v3, s50, v3
    v_bfe_u32 v5, v9, 1, 1
    v_add_u32 v6, 0, v5
    v_xor_b32 v6, v6, v4
    v_lshl_add_u32 v6, v6, 4, v3
    ds_read_b64_tr_b16 v[64:65], v6 offset:0
    ds_read_b64_tr_b16 v[66:67], v6 offset:2048
    ds_read_b64_tr_b16 v[68:69], v6 offset:4096
    ds_read_b64_tr_b16 v[70:71], v6 offset:6144
    v_add_u32 v6, 2, v5
    v_xor_b32 v6, v6, v4
    v_lshl_add_u32 v6, v6, 4, v3
    ds_read_b64_tr_b16 v[72:73], v6 offset:0
    ds_read_b64_tr_b16 v[74:75], v6 offset:2048
    ds_read_b64_tr_b16 v[76:77], v6 offset:4096
    ds_read_b64_tr_b16 v[78:79], v6 offset:6144
    v_add_u32 v6, 4, v5
    v_xor_b32 v6, v6, v4
    v_lshl_add_u32 v6, v6, 4, v3
    ds_read_b64_tr_b16 v[80:81], v6 offset:0
    ds_read_b64_tr_b16 v[82:83], v6 offset:2048
    ds_read_b64_tr_b16 v[84:85], v6 offset:4096
    ds_read_b64_tr_b16 v[86:87], v6 offset:6144
    v_add_u32 v6, 6, v5
    v_xor_b32 v6, v6, v4
    v_lshl_add_u32 v6, v6, 4, v3
    ds_read_b64_tr_b16 v[88:89], v6 offset:0
    ds_read_b64_tr_b16 v[90:91], v6 offset:2048
    ds_read_b64_tr_b16 v[92:93], v6 offset:4096
    ds_read_b64_tr_b16 v[94:95], v6 offset:6144
    s_waitcnt lgkmcnt(0)
    v_mfma_f32_16x16x32_bf16 v[28:31], v[12:15], v[64:67], 0
    v_mfma_f32_16x16x32_bf16 v[32:35], v[12:15], v[72:75], 0
    v_mfma_f32_16x16x32_bf16 v[36:39], v[12:15], v[80:83], 0
    v_mfma_f32_16x16x32_bf16 v[40:43], v[12:15], v[88:91], 0
    v_mfma_f32_16x16x32_bf16 v[28:31], v[16:19], v[68:71], v[28:31]
    v_mfma_f32_16x16x32_bf16 v[32:35], v[16:19], v[76:79], v[32:35]
    v_mfma_f32_16x16x32_bf16 v[36:39], v[16:19], v[84:87], v[36:39]
    v_mfma_f32_16x16x32_bf16 v[40:43], v[16:19], v[92:95], v[40:43]
    s_nop 7
    s_nop 1
    s_lshl_b32 s50, s40, 9
    v_lshl_add_u32 v3, v9, 2, s50
    v_add_u32 v3, 157696, v3
    s_mov_b64 exec, 0xffff
    ds_write_b32 v3, v28 offset:0
    ds_write_b32 v3, v29 offset:256
    ds_write_b32 v3, v32 offset:64
    ds_write_b32 v3, v33 offset:320
    ds_write_b32 v3, v36 offset:128
    ds_write_b32 v3, v37 offset:384
    ds_write_b32 v3, v40 offset:192
    ds_write_b32 v3, v41 offset:448
    s_mov_b64 exec, -1
    s_waitcnt lgkmcnt(0)
    s_barrier
    s_cmp_ge_u32 s40, 2
    s_cbranch_scc1 B3X_40
    v_lshlrev_b32 v3, 2, v0
    v_add_u32 v3, 157696, v3
    ds_read_b32 v64, v3 offset:0
    ds_read_b32 v65, v3 offset:512
    ds_read_b32 v66, v3 offset:1024
    ds_read_b32 v67, v3 offset:1536
    ds_read_b32 v68, v3 offset:2048
    ds_read_b32 v69, v3 offset:2560
    ds_read_b32 v70, v3 offset:3072
    ds_read_b32 v71, v3 offset:3584
    s_waitcnt lgkmcnt(0)
    v_add_f32 v64, v64, v68
    v_add_f32 v65, v65, v69
    v_add_f32 v66, v66, v70
    v_add_f32 v67, v67, v71
    v_add_f32 v64, v64, v66
    v_add_f32 v65, v65, v67
    v_add_f32 v64, v64, v65
    v_cvt_pk_bf16_f32 v6, v64, v64
    v_lshlrev_b32 v3, 1, v0
    v_add_u32 v3, 161792, v3
    ds_write_b16 v3, v6
B3X_40:
    s_waitcnt lgkmcnt(0)
    s_barrier
    v_mov_b32 v12, 0
    v_mov_b32 v13, 0
    v_mov_b32 v14, 0
    v_mov_b32 v15, 0
    v_mov_b32 v16, 0
    v_mov_b32 v17, 0
    v_mov_b32 v18, 0
    v_mov_b32 v19, 0
    v_lshlrev_b32 v3, 7, v9
    v_lshl_add_u32 v3, v10, 3, v3
    v_add_u32 v3, 161792, v3
    v_cmp_gt_u32 vcc, 2, v9
    s_and_saveexec_b64 s[58:59], vcc
    ds_read2_b64 v[12:15], v3 offset0:0 offset1:4
    ds_read2_b64 v[16:19], v3 offset0:8 offset1:12
    s_mov_b64 exec, s[58:59]
    v_lshrrev_b32 v3, 2, v9
    v_lshl_add_u32 v3, v10, 2, v3
    v_lshrrev_b32 v4, 1, v3
    v_and_b32 v4, 3, v4
    v_lshlrev_b32 v4, 1, v4
    v_mul_u32_u24 v3, 1152, v3
    v_and_b32 v5, 1, v9
    v_lshl_add_u32 v3, v5, 3, v3
    v_add_u32 v3, 65536, v3
    v_bfe_u32 v5, v9, 1, 1
    s_lshl_b32 s50, s40, 1
    v_add_u32 v5, s50, v5
    s_mul_i32 s51, s2, 2304
    s_add_u32 s51, s51, 0x60000
    s_lshl_b32 s52, s40, 6
    s_add_u32 s51, s51, s52
    v_lshl_add_u32 v7, v9, 2, s51
    v_add_u32 v6, 0, v5
    v_xor_b32 v6, v6, v4
    v_lshl_add_u32 v6, v6, 4, v3
    ds_read_b64_tr_b16 v[64:65], v6 offset:0
    ds_read_b64_tr_b16 v[66:67], v6 offset:18432
    ds_read_b64_tr_b16 v[68:69], v6 offset:36864
    ds_read_b64_tr_b16 v[70:71], v6 offset:55296
    s_waitcnt lgkmcnt(0)
    v_mfma_f32_16x16x32_bf16 v[28:31], v[12:15], v[64:67], 0
    v_mfma_f32_16x16x32_bf16 v[28:31], v[16:19], v[68:71], v[28:31]
    s_nop 7
    s_nop 1
    s_mov_b64 exec, 0xffff
    v_add_u32 v8, 0, v7
    global_store_dword v8, v28, s[36:37] sc1
    v_add_u32 v8, 147456, v8
    global_store_dword v8, v29, s[36:37] sc1
    s_mov_b64 exec, -1
    s_nop 1
    v_add_u32 v6, 16, v5
    v_xor_b32 v6, v6, v4
    v_lshl_add_u32 v6, v6, 4, v3
    ds_read_b64_tr_b16 v[64:65], v6 offset:0
    ds_read_b64_tr_b16 v[66:67], v6 offset:18432
    ds_read_b64_tr_b16 v[68:69], v6 offset:36864
    ds_read_b64_tr_b16 v[70:71], v6 offset:55296
    s_waitcnt lgkmcnt(0)
    v_mfma_f32_16x16x32_bf16 v[28:31], v[12:15], v[64:67], 0
    v_mfma_f32_16x16x32_bf16 v[28:31], v[16:19], v[68:71], v[28:31]
    s_nop 7
    s_nop 1
    s_mov_b64 exec, 0xffff
    v_add_u32 v8, 512, v7
    global_store_dword v8, v28, s[36:37] sc1
    v_add_u32 v8, 147456, v8
    global_store_dword v8, v29, s[36:37] sc1
    s_mov_b64 exec, -1
    s_nop 1
    v_add_u32 v6, 32, v5
    v_xor_b32 v6, v6, v4
    v_lshl_add_u32 v6, v6, 4, v3
    ds_read_b64_tr_b16 v[64:65], v6 offset:0
    ds_read_b64_tr_b16 v[66:67], v6 offset:18432
    ds_read_b64_tr_b16 v[68:69], v6 offset:36864
    ds_read_b64_tr_b16 v[70:71], v6 offset:55296
    s_waitcnt lgkmcnt(0)
    v_mfma_f32_16x16x32_bf16 v[28:31], v[12:15], v[64:67], 0
    v_mfma_f32_16x16x32_bf16 v[28:31], v[16:19], v[68:71], v[28:31]
    s_nop 7
    s_nop 1
    s_mov_b64 exec, 0xffff
    v_add_u32 v8, 1024, v7
    global_store_dword v8, v28, s[36:37] sc1
    v_add_u32 v8, 147456, v8
    global_store_dword v8, v29, s[36:37] sc1
    s_mov_b64 exec, -1
    s_nop 1
    v_add_u32 v6, 48, v5
    v_xor_b32 v6, v6, v4
    v_lshl_add_u32 v6, v6, 4, v3
    ds_read_b64_tr_b16 v[64:65], v6 offset:0
    ds_read_b64_tr_b16 v[66:67], v6 offset:18432
    ds_read_b64_tr_b16 v[68:69], v6 offset:36864
    ds_read_b64_tr_b16 v[70:71], v6 offset:55296
    s_waitcnt lgkmcnt(0)
    v_mfma_f32_16x16x32_bf16 v[28:31], v[12:15], v[64:67], 0
    v_mfma_f32_16x16x32_bf16 v[28:31], v[16:19], v[68:71], v[28:31]
    s_nop 7
    s_nop 1
    s_mov_b64 exec, 0xffff
    v_add_u32 v8, 1536, v7
    global_store_dword v8, v28, s[36:37] sc1
    v_add_u32 v8, 147456, v8
    global_store_dword v8, v29, s[36:37] sc1
    s_mov_b64 exec, -1
    s_nop 1
    s_cmp_ge_u32 s40, 4
    s_cbranch_scc1 B3K_41
    v_add_u32 v6, 64, v5
    v_xor_b32 v6, v6, v4
    v_lshl_add_u32 v6, v6, 4, v3
    ds_read_b64_tr_b16 v[64:65], v6 offset:0
    ds_read_b64_tr_b16 v[66:67], v6 offset:18432
    ds_read_b64_tr_b16 v[68:69], v6 offset:36864
    ds_read_b64_tr_b16 v[70:71], v6 offset:55296
    s_waitcnt lgkmcnt(0)
    v_mfma_f32_16x16x32_bf16 v[28:31], v[12:15], v[64:67], 0
    v_mfma_f32_16x16x32_bf16 v[28:31], v[16:19], v[68:71], v[28:31]
    s_nop 7
    s_nop 1
    s_mov_b64 exec, 0xffff
    v_add_u32 v8, 2048, v7
    global_store_dword v8, v28, s[36:37] sc1
    v_add_u32 v8, 147456, v8
    global_store_dword v8, v29, s[36:37] sc1
    s_mov_b64 exec, -1
    s_nop 1
B3K_41:
    s_waitcnt vmcnt(0)
    s_barrier
    s_cmp_lg_u32 s40, 0
    s_cbranch_scc1 L_B_END
    s_lshl_b32 s50, s2, 2
    s_add_u32 s50, s50, 0x386000
    v_lshl_add_u32 v5, v2, 8, s50
    v_mov_b32 v6, s92
    s_mov_b64 exec, 0xfff
    global_store_dword v5, v6, s[36:37] sc1
    s_mov_b64 exec, -1
L_B_END:
    s_waitcnt vmcnt(0)
L_END:
    s_endpgm
.section .rodata,"a"
.p2align 6
.amdhsa_kernel gated_mix__gqa_block_cached__compressed_kv_cla__decode_kernel
  .amdhsa_next_free_vgpr 256
  .amdhsa_next_free_sgpr 102
  .amdhsa_accum_offset 256
  .amdhsa_group_segment_fixed_size 0
  .amdhsa_kernarg_size 120
  .amdhsa_user_sgpr_count 2
  .amdhsa_user_sgpr_kernarg_segment_ptr 1
  .amdhsa_system_sgpr_workgroup_id_x 1
.end_amdhsa_kernel
```
